```python
import torch

def _softmax(x, axis=-1):
    return torch.softmax(x, dim=axis)
def _gelu(x):
    return torch.nn.functional.gelu(x, approximate="tanh")
def _silu(x):
    return torch.nn.functional.silu(x)
def _sigmoid(x):
    return torch.sigmoid(x)
def _layernorm(x, axis=-1, eps=1e-5):
    m = x.mean(dim=axis, keepdim=True)
    v = x.var(dim=axis, keepdim=True, unbiased=False)
    return (x - m) / torch.sqrt(v + eps)
def _scatter_add(tgt, idx, src, axis=0):
    return tgt.clone().index_add_(axis, idx, src)
def _segment_sum(src, seg, n):
    out = torch.zeros((n,) + src.shape[1:], dtype=src.dtype)
    return out.index_add_(0, seg, src)
def _pad(x, pw):
    flat = tuple(v for pair in reversed(pw) for v in pair)
    return torch.nn.functional.pad(x, flat)

kernel_name = 'standalone__gqa_softmax__near_ridge'

def setup_inputs():

    _w = (lambda a: (lambda t: t.to(torch.bfloat16) if t.is_floating_point() else t)(torch.as_tensor(a)))
    B, Hq, Hkv, Sq, Sk, D = 8, 16, 8, 384, 512, 256
    return {
        "q": _w((lambda *s: torch.randn(*s, dtype=torch.bfloat16) * 0.8)(B, Hq, Sq, D)),
        "k": _w((lambda *s: torch.randn(*s, dtype=torch.bfloat16) * 0.8)(B, Hkv, Sk, D)),
        "v": _w((lambda *s: torch.randn(*s, dtype=torch.bfloat16) * 0.05)(B, Hkv, Sk, D)),
    }

def reference(q, k, v):
    B, Hq, Sq, D = q.shape
    Hkv = k.shape[1]
    rep = Hq // Hkv
    k = (lambda x, n, axis: torch.repeat_interleave(x, n, dim=axis))(k, rep, axis=1)
    v = (lambda x, n, axis: torch.repeat_interleave(x, n, dim=axis))(v, rep, axis=1)
    scale = D ** -0.5
    scores = torch.einsum("bhqd,bhkd->bhqk", q, k) * scale
    p = _softmax(scores, axis=-1)
    return torch.einsum("bhqk,bhkd->bhqd", p, v)
```

```asm
; @launch grid=(256,1,1) block=(256,1,1) lds=163840
.amdgcn_target "amdgcn-amd-amdhsa--gfx950"
.text
.globl standalone__gqa_softmax__near_ridge_kernel
.p2align 12
.type standalone__gqa_softmax__near_ridge_kernel,@function
standalone__gqa_softmax__near_ridge_kernel:
    s_cmp_ge_u32 s2, 0x100
    s_cbranch_scc1 L_end
    s_load_dwordx2 s[8:9], s[0:1], 8
    s_load_dwordx2 s[4:5], s[0:1], 0
    s_load_dwordx2 s[12:13], s[0:1], 16
    s_load_dwordx2 s[16:17], s[0:1], 24
    v_lshrrev_b32 v8, 6, v0
    v_and_b32 v0, 63, v0
    v_readfirstlane_b32 s22, v8
    s_and_b32 s20, s2, 7
    s_lshr_b32 s21, s2, 3
    s_lshr_b32 s3, s21, 2
    s_and_b32 s46, s21, 3
    s_lshl_b32 s44, s3, 3
    s_add_u32 s44, s44, s20
    s_add_u32 s3, s3, s20
    s_mul_i32 s20, s44, 0x300
    s_mul_i32 s21, s46, 0xc0
    s_add_u32 s20, s20, s21
    s_mul_i32 s21, s22, 48
    s_add_u32 s20, s20, s21
    s_lshl_b32 s45, s20, 9
    s_lshl_b32 s44, s44, 18
    s_lshl_b32 s43, s46, 15
    s_and_b32 s21, s3, 3
    s_lshl_b32 s21, s21, 7
    s_add_u32 s24, s44, s21
    s_add_u32 s28, s45, s21
    s_add_u32 s29, s28, 0x2000
    s_add_u32 s30, s28, 0x4000
    s_lshl_b32 s23, s22, 11
    s_mul_i32 s99, s22, 0x1800
    s_add_u32 s99, s99, 0x20000
    v_lshrrev_b32 v9, 3, v0
    v_and_b32 v10, 6, v9
    v_and_b32 v18, 7, v0
    v_xor_b32 v10, v10, v18
    v_lshlrev_b32 v10, 4, v10
    v_lshl_add_u32 v7, v9, 9, v10
    v_add_u32 v11, 0xc00, v7
    v_lshl_add_u32 v1, v8, 13, v7
    v_add_u32 v2, 0xc00, v1
    s_mov_b32 s10, 0x1000000
    s_mov_b32 s11, 0x20000
    s_mov_b32 s6, 0x1800000
    s_mov_b32 s7, 0x20000
    s_waitcnt lgkmcnt(0)
    s_add_u32 s42, s24, s43
    s_add_u32 m0, s23, 0
    s_nop 0
    buffer_load_dwordx4 v1, s[8:11], s42 offen nt lds
    buffer_load_dwordx4 v2, s[8:11], s42 offen offset:1024 nt lds
    s_add_u32 m0, s99, 0
    s_nop 0
    buffer_load_dwordx4 v7, s[4:7], s28 offen nt lds
    buffer_load_dwordx4 v11, s[4:7], s28 offen offset:1024 nt lds
    s_add_u32 m0, s99, 0x800
    s_nop 0
    buffer_load_dwordx4 v7, s[4:7], s29 offen nt lds
    buffer_load_dwordx4 v11, s[4:7], s29 offen offset:1024 nt lds
    s_add_u32 m0, s99, 0x1000
    s_nop 0
    buffer_load_dwordx4 v7, s[4:7], s30 offen nt lds
    buffer_load_dwordx4 v11, s[4:7], s30 offen offset:1024 nt lds
    s_add_u32 s96, s46, 1
    s_and_b32 s96, s96, 3
    s_lshl_b32 s96, s96, 15
    s_add_u32 s42, s24, s96
    s_add_u32 m0, s23, 0x2000
    s_nop 0
    buffer_load_dwordx4 v1, s[8:11], s42 offen nt lds
    buffer_load_dwordx4 v2, s[8:11], s42 offen offset:1024 nt lds
    s_mov_b32 s14, 0x1000000
    s_mov_b32 s15, 0x20000
    s_mov_b32 s18, 0x1800000
    s_mov_b32 s19, 0x20000
    s_add_u32 s97, s46, 2
    s_and_b32 s97, s97, 3
    s_lshl_b32 s97, s97, 15
    s_add_u32 s98, s46, 3
    s_and_b32 s98, s98, 3
    s_lshl_b32 s98, s98, 15
    s_add_u32 s21, s3, 1
    s_and_b32 s21, s21, 3
    s_lshl_b32 s21, s21, 7
    s_add_u32 s25, s44, s21
    s_add_u32 s31, s45, s21
    s_add_u32 s32, s31, 0x2000
    s_add_u32 s33, s31, 0x4000
    s_add_u32 s21, s3, 2
    s_and_b32 s21, s21, 3
    s_lshl_b32 s21, s21, 7
    s_add_u32 s26, s44, s21
    s_add_u32 s34, s45, s21
    s_add_u32 s35, s34, 0x2000
    s_add_u32 s36, s34, 0x4000
    s_add_u32 s21, s3, 3
    s_and_b32 s21, s21, 3
    s_lshl_b32 s21, s21, 7
    s_add_u32 s27, s44, s21
    s_add_u32 s37, s45, s21
    s_add_u32 s38, s37, 0x2000
    s_add_u32 s39, s37, 0x4000
    v_and_b32 v9, 15, v0
    v_lshrrev_b32 v10, 4, v0
    v_and_b32 v18, 6, v0
    v_xor_b32 v18, v18, v10
    v_lshlrev_b32 v18, 4, v18
    v_lshl_add_u32 v5, v9, 7, v18
    v_xor_b32 v6, 64, v5
    v_add_u32 v3, s99, v5
    v_add_u32 v4, s99, v6
    s_mov_b32 s40, 0x3db8aa3b
    s_mov_b32 s41, 0x3db8aa3b
    v_mov_b32 v8, 0xff800000
    v_mov_b32 v12, 0
    v_mov_b32 v13, 0
    v_mov_b32 v9, 0xff800000
    v_mov_b32 v14, 0
    v_mov_b32 v15, 0
    v_mov_b32 v10, 0xff800000
    v_mov_b32 v16, 0
    v_mov_b32 v17, 0
    s_mov_b64 exec, 0
    s_cmp_eq_u32 s22, 0
    s_cbranch_scc1 L_pg1
    s_cmp_eq_u32 s22, 1
    s_cbranch_scc1 L_pg2
    s_cmp_eq_u32 s22, 2
    s_cbranch_scc1 L_pg3
    s_cmp_eq_u32 s22, 3
    s_cbranch_scc1 L_pg4
L_warm_done1:
    s_mov_b64 exec, -1
    s_add_u32 s42, s24, s97
    s_add_u32 m0, s23, 0x4000
    s_nop 0
    buffer_load_dwordx4 v1, s[8:11], s42 offen nt lds
    buffer_load_dwordx4 v2, s[8:11], s42 offen offset:1024 nt lds
    s_add_u32 s42, s24, s98
    s_add_u32 m0, s23, 0x6000
    s_nop 0
    buffer_load_dwordx4 v1, s[8:11], s42 offen nt lds
    buffer_load_dwordx4 v2, s[8:11], s42 offen offset:1024 nt lds
    s_getpc_b64 s[50:51]
    s_and_b32 s50, s50, 0xfffff000
    v_lshl_add_u32 v22, s22, 6, v0
    v_lshlrev_b32 v22, 7, v22
    v_add_u32 v21, 0, v22
    v_min_u32 v21, L_end-standalone__gqa_softmax__near_ridge_kernel, v21
    global_load_dword v23, v21, s[50:51]
    v_add_u32 v21, 0x8000, v22
    v_min_u32 v21, L_end-standalone__gqa_softmax__near_ridge_kernel, v21
    global_load_dword v23, v21, s[50:51]
    s_add_u32 s47, s25, 0
    s_add_u32 s21, s26, 0x20000
    s_cmp_eq_u32 s22, 1
    s_cselect_b32 s47, s21, s47
    s_add_u32 s21, s26, 0
    s_cmp_eq_u32 s22, 2
    s_cselect_b32 s47, s21, s47
    s_add_u32 s21, s27, 0x20000
    s_cmp_eq_u32 s22, 3
    s_cselect_b32 s47, s21, s47
    s_add_u32 s47, s47, s43
    s_lshl_b32 s21, s22, 13
    s_add_u32 s48, s27, 0
    s_add_u32 s48, s48, s43
    s_add_u32 s48, s48, s21
    v_lshlrev_b32 v22, 9, v0
    s_waitcnt vmcnt(14)
    s_barrier
    ds_read_b128 a[224:227], v5 offset:0
    ds_read_b128 a[228:231], v6 offset:0
    ds_read_b128 a[232:235], v5 offset:2048
    ds_read_b128 a[236:239], v6 offset:2048
    ds_read_b128 a[240:243], v5 offset:4096
    ds_read_b128 a[244:247], v6 offset:4096
    s_waitcnt vmcnt(12)
    ds_read_b128 a[152:155], v3 offset:0
    ds_read_b128 a[156:159], v4 offset:0
    s_waitcnt vmcnt(10)
    ds_read_b128 a[160:163], v3 offset:2048
    ds_read_b128 a[164:167], v4 offset:2048
    s_waitcnt vmcnt(8)
    ds_read_b128 a[168:171], v3 offset:4096
    ds_read_b128 a[172:175], v4 offset:4096
    s_waitcnt lgkmcnt(4)
    v_mfma_f32_16x16x32_bf16 a[0:3], a[224:227], a[152:155], 0
    s_add_u32 s42, s24, s43
    ds_read_b128 a[248:251], v5 offset:6144
    v_mfma_f32_16x16x32_bf16 a[0:3], a[228:231], a[156:159], a[0:3]
    s_waitcnt lgkmcnt(3)
    ds_read_b128 a[252:255], v6 offset:6144
    v_mfma_f32_16x16x32_bf16 a[8:11], a[224:227], a[160:163], 0
    s_add_u32 s42, s42, 0x20000
    v_mfma_f32_16x16x32_bf16 a[8:11], a[228:231], a[164:167], a[8:11]
    s_waitcnt lgkmcnt(2)
    v_mfma_f32_16x16x32_bf16 a[16:19], a[224:227], a[168:171], 0
    s_add_u32 m0, s23, 0x8000
    v_mfma_f32_16x16x32_bf16 a[16:19], a[228:231], a[172:175], a[16:19]
    buffer_load_dwordx4 v1, s[8:11], s42 offen nt lds
    v_mfma_f32_16x16x32_bf16 a[4:7], a[232:235], a[152:155], 0
    s_waitcnt vmcnt(7)
    s_barrier
    ds_read_b128 a[224:227], v5 offset:8192
    v_mfma_f32_16x16x32_bf16 a[4:7], a[236:239], a[156:159], a[4:7]
    ds_read_b128 a[228:231], v6 offset:8192
    v_mfma_f32_16x16x32_bf16 a[12:15], a[232:235], a[160:163], 0
    v_mfma_f32_16x16x32_bf16 a[12:15], a[236:239], a[164:167], a[12:15]
    buffer_load_dwordx4 v2, s[8:11], s42 offen offset:1024 nt lds
    v_mfma_f32_16x16x32_bf16 a[20:23], a[232:235], a[168:171], 0
    s_add_u32 s42, s24, s96
    v_mfma_f32_16x16x32_bf16 a[20:23], a[236:239], a[172:175], a[20:23]
    s_add_u32 s42, s42, 0x20000
    v_mfma_f32_16x16x32_bf16 a[24:27], a[240:243], a[152:155], 0
    s_add_u32 m0, s23, 0xa000
    ds_read_b128 a[232:235], v5 offset:10240
    v_mfma_f32_16x16x32_bf16 a[24:27], a[244:247], a[156:159], a[24:27]
    ds_read_b128 a[236:239], v6 offset:10240
    v_mfma_f32_16x16x32_bf16 a[32:35], a[240:243], a[160:163], 0
    buffer_load_dwordx4 v1, s[8:11], s42 offen nt lds
    v_mfma_f32_16x16x32_bf16 a[32:35], a[244:247], a[164:167], a[32:35]
    v_mfma_f32_16x16x32_bf16 a[40:43], a[240:243], a[168:171], 0
    v_mfma_f32_16x16x32_bf16 a[40:43], a[244:247], a[172:175], a[40:43]
    s_waitcnt lgkmcnt(4)
    v_mfma_f32_16x16x32_bf16 a[28:31], a[248:251], a[152:155], 0
    ds_read_b128 a[240:243], v5 offset:12288
    v_mfma_f32_16x16x32_bf16 a[28:31], a[252:255], a[156:159], a[28:31]
    ds_read_b128 a[244:247], v6 offset:12288
    v_mfma_f32_16x16x32_bf16 a[36:39], a[248:251], a[160:163], 0
    buffer_load_dwordx4 v2, s[8:11], s42 offen offset:1024 nt lds
    v_mfma_f32_16x16x32_bf16 a[36:39], a[252:255], a[164:167], a[36:39]
    s_add_u32 m0, s99, 0
    v_mfma_f32_16x16x32_bf16 a[44:47], a[248:251], a[168:171], 0
    v_mfma_f32_16x16x32_bf16 a[44:47], a[252:255], a[172:175], a[44:47]
    s_waitcnt lgkmcnt(4)
    v_mfma_f32_16x16x32_bf16 a[48:51], a[224:227], a[152:155], 0
    ds_read_b128 a[248:251], v5 offset:14336
    v_mfma_f32_16x16x32_bf16 a[48:51], a[228:231], a[156:159], a[48:51]
    ds_read_b128 a[252:255], v6 offset:14336
    v_mfma_f32_16x16x32_bf16 a[56:59], a[224:227], a[160:163], 0
    buffer_load_dwordx4 v7, s[4:7], s31 offen nt lds
    v_mfma_f32_16x16x32_bf16 a[56:59], a[228:231], a[164:167], a[56:59]
    v_mfma_f32_16x16x32_bf16 a[64:67], a[224:227], a[168:171], 0
    v_mfma_f32_16x16x32_bf16 a[64:67], a[228:231], a[172:175], a[64:67]
    s_waitcnt lgkmcnt(4)
    v_mfma_f32_16x16x32_bf16 a[52:55], a[232:235], a[152:155], 0
    s_waitcnt vmcnt(9)
    s_barrier
    ds_read_b128 a[224:227], v5 offset:16384
    v_mfma_f32_16x16x32_bf16 a[52:55], a[236:239], a[156:159], a[52:55]
    ds_read_b128 a[228:231], v6 offset:16384
    v_mfma_f32_16x16x32_bf16 a[60:63], a[232:235], a[160:163], 0
    buffer_load_dwordx4 v11, s[4:7], s31 offen offset:1024 nt lds
    v_mfma_f32_16x16x32_bf16 a[60:63], a[236:239], a[164:167], a[60:63]
    s_add_u32 s42, s24, s97
    v_mfma_f32_16x16x32_bf16 a[68:71], a[232:235], a[168:171], 0
    s_add_u32 s42, s42, 0x20000
    v_mfma_f32_16x16x32_bf16 a[68:71], a[236:239], a[172:175], a[68:71]
    s_waitcnt lgkmcnt(4)
    v_mfma_f32_16x16x32_bf16 a[72:75], a[240:243], a[152:155], 0
    s_add_u32 m0, s23, 0xc000
    ds_read_b128 a[232:235], v5 offset:18432
    v_mfma_f32_16x16x32_bf16 a[72:75], a[244:247], a[156:159], a[72:75]
    ds_read_b128 a[236:239], v6 offset:18432
    v_mfma_f32_16x16x32_bf16 a[80:83], a[240:243], a[160:163], 0
    buffer_load_dwordx4 v1, s[8:11], s42 offen nt lds
    v_mfma_f32_16x16x32_bf16 a[80:83], a[244:247], a[164:167], a[80:83]
    v_mfma_f32_16x16x32_bf16 a[88:91], a[240:243], a[168:171], 0
    v_mfma_f32_16x16x32_bf16 a[88:91], a[244:247], a[172:175], a[88:91]
    s_waitcnt lgkmcnt(4)
    v_mfma_f32_16x16x32_bf16 a[76:79], a[248:251], a[152:155], 0
    ds_read_b128 a[240:243], v5 offset:20480
    v_mfma_f32_16x16x32_bf16 a[76:79], a[252:255], a[156:159], a[76:79]
    ds_read_b128 a[244:247], v6 offset:20480
    v_mfma_f32_16x16x32_bf16 a[84:87], a[248:251], a[160:163], 0
    buffer_load_dwordx4 v2, s[8:11], s42 offen offset:1024 nt lds
    v_mfma_f32_16x16x32_bf16 a[84:87], a[252:255], a[164:167], a[84:87]
    s_add_u32 s42, s24, s98
    v_mfma_f32_16x16x32_bf16 a[92:95], a[248:251], a[168:171], 0
    s_add_u32 s42, s42, 0x20000
    v_mfma_f32_16x16x32_bf16 a[92:95], a[252:255], a[172:175], a[92:95]
    s_waitcnt lgkmcnt(4)
    v_mfma_f32_16x16x32_bf16 a[96:99], a[224:227], a[152:155], 0
    s_add_u32 m0, s23, 0xe000
    ds_read_b128 a[248:251], v5 offset:22528
    v_mfma_f32_16x16x32_bf16 a[96:99], a[228:231], a[156:159], a[96:99]
    ds_read_b128 a[252:255], v6 offset:22528
    v_mfma_f32_16x16x32_bf16 a[104:107], a[224:227], a[160:163], 0
    buffer_load_dwordx4 v1, s[8:11], s42 offen nt lds
    v_mfma_f32_16x16x32_bf16 a[104:107], a[228:231], a[164:167], a[104:107]
    v_mfma_f32_16x16x32_bf16 a[112:115], a[224:227], a[168:171], 0
    v_mfma_f32_16x16x32_bf16 a[112:115], a[228:231], a[172:175], a[112:115]
    s_waitcnt lgkmcnt(4)
    v_mfma_f32_16x16x32_bf16 a[100:103], a[232:235], a[152:155], 0
    s_waitcnt vmcnt(11)
    s_barrier
    ds_read_b128 a[224:227], v5 offset:24576
    v_mfma_f32_16x16x32_bf16 a[100:103], a[236:239], a[156:159], a[100:103]
    ds_read_b128 a[228:231], v6 offset:24576
    v_mfma_f32_16x16x32_bf16 a[108:111], a[232:235], a[160:163], 0
    buffer_load_dwordx4 v2, s[8:11], s42 offen offset:1024 nt lds
    v_mfma_f32_16x16x32_bf16 a[108:111], a[236:239], a[164:167], a[108:111]
    s_add_u32 s42, s25, s43
    v_mfma_f32_16x16x32_bf16 a[116:119], a[232:235], a[168:171], 0
    s_add_u32 m0, s23, 0x10000
    v_mfma_f32_16x16x32_bf16 a[116:119], a[236:239], a[172:175], a[116:119]
    s_waitcnt lgkmcnt(4)
    v_mfma_f32_16x16x32_bf16 a[120:123], a[240:243], a[152:155], 0
    ds_read_b128 a[232:235], v5 offset:26624
    v_mfma_f32_16x16x32_bf16 a[120:123], a[244:247], a[156:159], a[120:123]
    ds_read_b128 a[236:239], v6 offset:26624
    v_mfma_f32_16x16x32_bf16 a[128:131], a[240:243], a[160:163], 0
    buffer_load_dwordx4 v1, s[8:11], s42 offen nt lds
    v_mfma_f32_16x16x32_bf16 a[128:131], a[244:247], a[164:167], a[128:131]
    v_mfma_f32_16x16x32_bf16 a[136:139], a[240:243], a[168:171], 0
    v_mfma_f32_16x16x32_bf16 a[136:139], a[244:247], a[172:175], a[136:139]
    s_waitcnt lgkmcnt(4)
    v_mfma_f32_16x16x32_bf16 a[124:127], a[248:251], a[152:155], 0
    ds_read_b128 a[240:243], v5 offset:28672
    v_mfma_f32_16x16x32_bf16 a[124:127], a[252:255], a[156:159], a[124:127]
    ds_read_b128 a[244:247], v6 offset:28672
    v_mfma_f32_16x16x32_bf16 a[132:135], a[248:251], a[160:163], 0
    buffer_load_dwordx4 v2, s[8:11], s42 offen offset:1024 nt lds
    v_mfma_f32_16x16x32_bf16 a[132:135], a[252:255], a[164:167], a[132:135]
    s_add_u32 m0, s99, 0x800
    v_mfma_f32_16x16x32_bf16 a[140:143], a[248:251], a[168:171], 0
    v_mfma_f32_16x16x32_bf16 a[140:143], a[252:255], a[172:175], a[140:143]
    s_waitcnt lgkmcnt(4)
    v_mfma_f32_16x16x32_bf16 a[144:147], a[224:227], a[152:155], 0
    ds_read_b128 a[248:251], v5 offset:30720
    v_mfma_f32_16x16x32_bf16 a[144:147], a[228:231], a[156:159], a[144:147]
    ds_read_b128 a[252:255], v6 offset:30720
    v_mfma_f32_16x16x32_bf16 v[24:27], a[224:227], a[160:163], 0
    buffer_load_dwordx4 v7, s[4:7], s32 offen nt lds
    v_mfma_f32_16x16x32_bf16 v[24:27], a[228:231], a[164:167], v[24:27]
    v_mfma_f32_16x16x32_bf16 v[32:35], a[224:227], a[168:171], 0
    v_mfma_f32_16x16x32_bf16 v[32:35], a[228:231], a[172:175], v[32:35]
    s_waitcnt lgkmcnt(4)
    v_mfma_f32_16x16x32_bf16 a[148:151], a[232:235], a[152:155], 0
    s_mov_b64 exec, 0
    s_cmp_eq_u32 s22, 0
    s_cbranch_scc1 L_pg5
    s_cmp_eq_u32 s22, 1
    s_cbranch_scc1 L_pg6
    s_cmp_eq_u32 s22, 2
    s_cbranch_scc1 L_pg7
    s_cmp_eq_u32 s22, 3
    s_cbranch_scc1 L_pg8
L_warm_done:
    s_mov_b64 exec, -1
    s_nop 3
    s_waitcnt vmcnt(3)
    s_barrier
    v_mfma_f32_16x16x32_bf16 a[148:151], a[236:239], a[156:159], a[148:151]
    ds_read_b128 a[224:227], v5 offset:32768
    v_mfma_f32_16x16x32_bf16 v[28:31], a[232:235], a[160:163], 0
    ds_read_b128 a[228:231], v6 offset:32768
    v_mfma_f32_16x16x32_bf16 v[28:31], a[236:239], a[164:167], v[28:31]
    buffer_load_dwordx4 v11, s[4:7], s32 offen offset:1024 nt lds
    v_mfma_f32_16x16x32_bf16 v[36:39], a[232:235], a[168:171], 0
    s_add_u32 s42, s25, s96
    v_mfma_f32_16x16x32_bf16 v[36:39], a[236:239], a[172:175], v[36:39]
    s_waitcnt lgkmcnt(4)
    v_mfma_f32_16x16x32_bf16 v[40:43], a[240:243], a[152:155], 0
    s_add_u32 m0, s23, 0x12000
    ds_read_b128 a[232:235], v5 offset:34816
    v_mfma_f32_16x16x32_bf16 v[40:43], a[244:247], a[156:159], v[40:43]
    ds_read_b128 a[236:239], v6 offset:34816
    v_mfma_f32_16x16x32_bf16 v[48:51], a[240:243], a[160:163], 0
    buffer_load_dwordx4 v1, s[8:11], s42 offen nt lds
    v_mfma_f32_16x16x32_bf16 v[48:51], a[244:247], a[164:167], v[48:51]
    v_mfma_f32_16x16x32_bf16 v[56:59], a[240:243], a[168:171], 0
    v_mfma_f32_16x16x32_bf16 v[56:59], a[244:247], a[172:175], v[56:59]
    s_waitcnt lgkmcnt(4)
    v_mfma_f32_16x16x32_bf16 v[44:47], a[248:251], a[152:155], 0
    ds_read_b128 a[240:243], v5 offset:36864
    v_mfma_f32_16x16x32_bf16 v[44:47], a[252:255], a[156:159], v[44:47]
    ds_read_b128 a[244:247], v6 offset:36864
    v_mfma_f32_16x16x32_bf16 v[52:55], a[248:251], a[160:163], 0
    buffer_load_dwordx4 v2, s[8:11], s42 offen offset:1024 nt lds
    v_mfma_f32_16x16x32_bf16 v[52:55], a[252:255], a[164:167], v[52:55]
    s_add_u32 s42, s25, s97
    v_mfma_f32_16x16x32_bf16 v[60:63], a[248:251], a[168:171], 0
    s_add_u32 m0, s23, 0x14000
    v_mfma_f32_16x16x32_bf16 v[60:63], a[252:255], a[172:175], v[60:63]
    s_waitcnt lgkmcnt(4)
    v_mfma_f32_16x16x32_bf16 v[64:67], a[224:227], a[152:155], 0
    ds_read_b128 a[248:251], v5 offset:38912
    v_mfma_f32_16x16x32_bf16 v[64:67], a[228:231], a[156:159], v[64:67]
    ds_read_b128 a[252:255], v6 offset:38912
    v_mfma_f32_16x16x32_bf16 v[72:75], a[224:227], a[160:163], 0
    buffer_load_dwordx4 v1, s[8:11], s42 offen nt lds
    v_mfma_f32_16x16x32_bf16 v[72:75], a[228:231], a[164:167], v[72:75]
    v_mfma_f32_16x16x32_bf16 v[80:83], a[224:227], a[168:171], 0
    v_mfma_f32_16x16x32_bf16 v[80:83], a[228:231], a[172:175], v[80:83]
    s_waitcnt lgkmcnt(4)
    v_mfma_f32_16x16x32_bf16 v[68:71], a[232:235], a[152:155], 0
    ds_read_b128 a[224:227], v5 offset:40960
    v_mfma_f32_16x16x32_bf16 v[68:71], a[236:239], a[156:159], v[68:71]
    ds_read_b128 a[228:231], v6 offset:40960
    v_mfma_f32_16x16x32_bf16 v[76:79], a[232:235], a[160:163], 0
    buffer_load_dwordx4 v2, s[8:11], s42 offen offset:1024 nt lds
    v_mfma_f32_16x16x32_bf16 v[76:79], a[236:239], a[164:167], v[76:79]
    s_add_u32 m0, s99, 0x1000
    v_mfma_f32_16x16x32_bf16 v[84:87], a[232:235], a[168:171], 0
    v_mfma_f32_16x16x32_bf16 v[84:87], a[236:239], a[172:175], v[84:87]
    s_waitcnt lgkmcnt(4)
    v_mfma_f32_16x16x32_bf16 v[88:91], a[240:243], a[152:155], 0
    ds_read_b128 a[232:235], v5 offset:43008
    v_mfma_f32_16x16x32_bf16 v[88:91], a[244:247], a[156:159], v[88:91]
    ds_read_b128 a[236:239], v6 offset:43008
    v_mfma_f32_16x16x32_bf16 v[96:99], a[240:243], a[160:163], 0
    buffer_load_dwordx4 v7, s[4:7], s33 offen nt lds
    v_mfma_f32_16x16x32_bf16 v[96:99], a[244:247], a[164:167], v[96:99]
    v_mfma_f32_16x16x32_bf16 v[104:107], a[240:243], a[168:171], 0
    v_mfma_f32_16x16x32_bf16 v[104:107], a[244:247], a[172:175], v[104:107]
    s_waitcnt lgkmcnt(4)
    v_mfma_f32_16x16x32_bf16 v[92:95], a[248:251], a[152:155], 0
    ds_read_b128 a[240:243], v5 offset:45056
    v_mfma_f32_16x16x32_bf16 v[92:95], a[252:255], a[156:159], v[92:95]
    ds_read_b128 a[244:247], v6 offset:45056
    v_mfma_f32_16x16x32_bf16 v[100:103], a[248:251], a[160:163], 0
    buffer_load_dwordx4 v11, s[4:7], s33 offen offset:1024 nt lds
    v_mfma_f32_16x16x32_bf16 v[100:103], a[252:255], a[164:167], v[100:103]
    s_add_u32 s42, s25, s98
    v_mfma_f32_16x16x32_bf16 v[108:111], a[248:251], a[168:171], 0
    s_add_u32 m0, s23, 0x16000
    v_mfma_f32_16x16x32_bf16 v[108:111], a[252:255], a[172:175], v[108:111]
    s_waitcnt lgkmcnt(4)
    v_mfma_f32_16x16x32_bf16 v[112:115], a[224:227], a[152:155], 0
    ds_read_b128 a[248:251], v5 offset:47104
    v_mfma_f32_16x16x32_bf16 v[112:115], a[228:231], a[156:159], v[112:115]
    ds_read_b128 a[252:255], v6 offset:47104
    v_mfma_f32_16x16x32_bf16 v[120:123], a[224:227], a[160:163], 0
    buffer_load_dwordx4 v1, s[8:11], s42 offen nt lds
    v_mfma_f32_16x16x32_bf16 v[120:123], a[228:231], a[164:167], v[120:123]
    v_mfma_f32_16x16x32_bf16 v[128:131], a[224:227], a[168:171], 0
    v_mfma_f32_16x16x32_bf16 v[128:131], a[228:231], a[172:175], v[128:131]
    s_waitcnt lgkmcnt(4)
    v_mfma_f32_16x16x32_bf16 v[116:119], a[232:235], a[152:155], 0
    ds_read_b128 a[224:227], v5 offset:49152
    v_mfma_f32_16x16x32_bf16 v[116:119], a[236:239], a[156:159], v[116:119]
    ds_read_b128 a[228:231], v6 offset:49152
    v_mfma_f32_16x16x32_bf16 v[124:127], a[232:235], a[160:163], 0
    buffer_load_dwordx4 v2, s[8:11], s42 offen offset:1024 nt lds
    v_mfma_f32_16x16x32_bf16 v[124:127], a[236:239], a[164:167], v[124:127]
    s_add_u32 s42, s25, s43
    v_mfma_f32_16x16x32_bf16 v[132:135], a[232:235], a[168:171], 0
    s_add_u32 s42, s42, 0x20000
    v_mfma_f32_16x16x32_bf16 v[132:135], a[236:239], a[172:175], v[132:135]
    s_waitcnt lgkmcnt(4)
    v_mfma_f32_16x16x32_bf16 v[136:139], a[240:243], a[152:155], 0
    s_add_u32 m0, s23, 0x18000
    ds_read_b128 a[232:235], v5 offset:51200
    v_mfma_f32_16x16x32_bf16 v[136:139], a[244:247], a[156:159], v[136:139]
    ds_read_b128 a[236:239], v6 offset:51200
    v_mfma_f32_16x16x32_bf16 v[144:147], a[240:243], a[160:163], 0
    buffer_load_dwordx4 v1, s[8:11], s42 offen nt lds
    v_mfma_f32_16x16x32_bf16 v[144:147], a[244:247], a[164:167], v[144:147]
    v_mfma_f32_16x16x32_bf16 v[152:155], a[240:243], a[168:171], 0
    v_mfma_f32_16x16x32_bf16 v[152:155], a[244:247], a[172:175], v[152:155]
    s_waitcnt lgkmcnt(4)
    v_mfma_f32_16x16x32_bf16 v[140:143], a[248:251], a[152:155], 0
    ds_read_b128 a[240:243], v5 offset:53248
    v_mfma_f32_16x16x32_bf16 v[140:143], a[252:255], a[156:159], v[140:143]
    ds_read_b128 a[244:247], v6 offset:53248
    v_mfma_f32_16x16x32_bf16 v[148:151], a[248:251], a[160:163], 0
    buffer_load_dwordx4 v2, s[8:11], s42 offen offset:1024 nt lds
    v_mfma_f32_16x16x32_bf16 v[148:151], a[252:255], a[164:167], v[148:151]
    s_add_u32 s42, s25, s96
    v_mfma_f32_16x16x32_bf16 v[156:159], a[248:251], a[168:171], 0
    s_add_u32 s42, s42, 0x20000
    v_mfma_f32_16x16x32_bf16 v[156:159], a[252:255], a[172:175], v[156:159]
    s_waitcnt lgkmcnt(4)
    v_mfma_f32_16x16x32_bf16 v[160:163], a[224:227], a[152:155], 0
    s_add_u32 m0, s23, 0x1a000
    ds_read_b128 a[248:251], v5 offset:55296
    v_mfma_f32_16x16x32_bf16 v[160:163], a[228:231], a[156:159], v[160:163]
    ds_read_b128 a[252:255], v6 offset:55296
    v_mfma_f32_16x16x32_bf16 v[168:171], a[224:227], a[160:163], 0
    buffer_load_dwordx4 v1, s[8:11], s42 offen nt lds
    v_mfma_f32_16x16x32_bf16 v[168:171], a[228:231], a[164:167], v[168:171]
    ds_read_b128 a[176:179], v3 offset:0
    v_mfma_f32_16x16x32_bf16 v[176:179], a[224:227], a[168:171], 0
    ds_read_b128 a[180:183], v4 offset:0
    v_mfma_f32_16x16x32_bf16 v[176:179], a[228:231], a[172:175], v[176:179]
    s_waitcnt lgkmcnt(6)
    v_mfma_f32_16x16x32_bf16 v[164:167], a[232:235], a[152:155], 0
    ds_read_b128 a[224:227], v5 offset:57344
    v_mfma_f32_16x16x32_bf16 v[164:167], a[236:239], a[156:159], v[164:167]
    ds_read_b128 a[228:231], v6 offset:57344
    v_mfma_f32_16x16x32_bf16 v[172:175], a[232:235], a[160:163], 0
    buffer_load_dwordx4 v2, s[8:11], s42 offen offset:1024 nt lds
    v_mfma_f32_16x16x32_bf16 v[172:175], a[236:239], a[164:167], v[172:175]
    s_add_u32 s42, s25, s97
    v_mfma_f32_16x16x32_bf16 v[180:183], a[232:235], a[168:171], 0
    s_add_u32 s42, s42, 0x20000
    v_mfma_f32_16x16x32_bf16 v[180:183], a[236:239], a[172:175], v[180:183]
    s_waitcnt lgkmcnt(6)
    v_mfma_f32_16x16x32_bf16 v[184:187], a[240:243], a[152:155], 0
    s_add_u32 m0, s23, 0x1c000
    ds_read_b128 a[232:235], v5 offset:59392
    v_mfma_f32_16x16x32_bf16 v[184:187], a[244:247], a[156:159], v[184:187]
    ds_read_b128 a[236:239], v6 offset:59392
    v_mfma_f32_16x16x32_bf16 v[192:195], a[240:243], a[160:163], 0
    buffer_load_dwordx4 v1, s[8:11], s42 offen nt lds
    v_mfma_f32_16x16x32_bf16 v[192:195], a[244:247], a[164:167], v[192:195]
    v_mfma_f32_16x16x32_bf16 v[200:203], a[240:243], a[168:171], 0
    v_mfma_f32_16x16x32_bf16 v[200:203], a[244:247], a[172:175], v[200:203]
    s_waitcnt lgkmcnt(6)
    v_mfma_f32_16x16x32_bf16 v[188:191], a[248:251], a[152:155], 0
    ds_read_b128 a[240:243], v5 offset:61440
    v_mfma_f32_16x16x32_bf16 v[188:191], a[252:255], a[156:159], v[188:191]
    ds_read_b128 a[244:247], v6 offset:61440
    v_mfma_f32_16x16x32_bf16 v[196:199], a[248:251], a[160:163], 0
    buffer_load_dwordx4 v2, s[8:11], s42 offen offset:1024 nt lds
    v_mfma_f32_16x16x32_bf16 v[196:199], a[252:255], a[164:167], v[196:199]
    s_add_u32 s42, s25, s98
    v_mfma_f32_16x16x32_bf16 v[204:207], a[248:251], a[168:171], 0
    s_add_u32 s42, s42, 0x20000
    v_mfma_f32_16x16x32_bf16 v[204:207], a[252:255], a[172:175], v[204:207]
    s_waitcnt lgkmcnt(4)
    v_mfma_f32_16x16x32_bf16 v[208:211], a[224:227], a[152:155], 0
    s_add_u32 m0, s23, 0x1e000
    ds_read_b128 a[248:251], v5 offset:63488
    v_mfma_f32_16x16x32_bf16 v[208:211], a[228:231], a[156:159], v[208:211]
    ds_read_b128 a[252:255], v6 offset:63488
    v_mfma_f32_16x16x32_bf16 v[216:219], a[224:227], a[160:163], 0
    buffer_load_dwordx4 v1, s[8:11], s42 offen nt lds
    v_mfma_f32_16x16x32_bf16 v[216:219], a[228:231], a[164:167], v[216:219]
    s_waitcnt vmcnt(15)
    ds_read_b128 a[184:187], v3 offset:2048
    v_mfma_f32_16x16x32_bf16 v[224:227], a[224:227], a[168:171], 0
    ds_read_b128 a[188:191], v4 offset:2048
    v_mfma_f32_16x16x32_bf16 v[224:227], a[228:231], a[172:175], v[224:227]
    s_waitcnt lgkmcnt(6)
    v_mfma_f32_16x16x32_bf16 v[212:215], a[232:235], a[152:155], 0
    s_waitcnt vmcnt(7)
    s_barrier
    buffer_load_dwordx4 v2, s[8:11], s42 offen offset:1024 nt lds
    v_mfma_f32_16x16x32_bf16 v[212:215], a[236:239], a[156:159], v[212:215]
    ds_read_b128 a[192:195], v3 offset:4096
    v_add_u32 v5, 0x10000, v5
    v_mfma_f32_16x16x32_bf16 v[220:223], a[232:235], a[160:163], 0
    s_add_u32 m0, s99, 0
    ds_read_b128 a[196:199], v4 offset:4096
    v_add_u32 v6, 0x10000, v6
    v_mfma_f32_16x16x32_bf16 v[220:223], a[236:239], a[164:167], v[220:223]
    ds_read_b128 a[224:227], v5 offset:0
    v_mfma_f32_16x16x32_bf16 v[228:231], a[232:235], a[168:171], 0
    ds_read_b128 a[228:231], v6 offset:0
    v_mfma_f32_16x16x32_bf16 v[228:231], a[236:239], a[172:175], v[228:231]
    s_waitcnt lgkmcnt(8)
    buffer_load_dwordx4 v7, s[4:7], s34 offen nt lds
    v_mfma_f32_16x16x32_bf16 v[232:235], a[240:243], a[152:155], 0
    ds_read_b128 a[232:235], v5 offset:2048
    v_mfma_f32_16x16x32_bf16 v[232:235], a[244:247], a[156:159], v[232:235]
    ds_read_b128 a[236:239], v6 offset:2048
    v_mfma_f32_16x16x32_bf16 v[240:243], a[240:243], a[160:163], 0
    v_mfma_f32_16x16x32_bf16 v[240:243], a[244:247], a[164:167], v[240:243]
    buffer_load_dwordx4 v11, s[4:7], s34 offen offset:1024 nt lds
    v_mfma_f32_16x16x32_bf16 v[248:251], a[240:243], a[168:171], 0
    v_mfma_f32_16x16x32_bf16 v[248:251], a[244:247], a[172:175], v[248:251]
    s_waitcnt lgkmcnt(8)
    v_mfma_f32_16x16x32_bf16 v[236:239], a[248:251], a[152:155], 0
    ds_read_b128 a[240:243], v5 offset:4096
    v_mfma_f32_16x16x32_bf16 v[236:239], a[252:255], a[156:159], v[236:239]
    ds_read_b128 a[244:247], v6 offset:4096
    v_mfma_f32_16x16x32_bf16 v[244:247], a[248:251], a[160:163], 0
    s_add_u32 s42, s26, s43
    v_mfma_f32_16x16x32_bf16 v[244:247], a[252:255], a[164:167], v[244:247]
    s_add_u32 m0, s23, 0
    v_mfma_f32_16x16x32_bf16 v[252:255], a[248:251], a[168:171], 0
    v_mfma_f32_16x16x32_bf16 v[252:255], a[252:255], a[172:175], v[252:255]
    s_waitcnt lgkmcnt(4)
    buffer_load_dwordx4 v1, s[8:11], s42 offen nt lds
    v_mfma_f32_16x16x32_bf16 a[0:3], a[224:227], a[176:179], a[0:3]
    ds_read_b128 a[248:251], v5 offset:6144
    v_mfma_f32_16x16x32_bf16 a[0:3], a[228:231], a[180:183], a[0:3]
    ds_read_b128 a[252:255], v6 offset:6144
    v_mfma_f32_16x16x32_bf16 a[8:11], a[224:227], a[184:187], a[8:11]
    v_mfma_f32_16x16x32_bf16 a[8:11], a[228:231], a[188:191], a[8:11]
    buffer_load_dwordx4 v2, s[8:11], s42 offen offset:1024 nt lds
    v_mfma_f32_16x16x32_bf16 a[16:19], a[224:227], a[192:195], a[16:19]
    s_add_u32 m0, s99, 0x800
    v_mfma_f32_16x16x32_bf16 a[16:19], a[228:231], a[196:199], a[16:19]
    s_waitcnt lgkmcnt(4)
    v_mfma_f32_16x16x32_bf16 a[4:7], a[232:235], a[176:179], a[4:7]
    ds_read_b128 a[224:227], v5 offset:8192
    v_mfma_f32_16x16x32_bf16 a[4:7], a[236:239], a[180:183], a[4:7]
    ds_read_b128 a[228:231], v6 offset:8192
    v_mfma_f32_16x16x32_bf16 a[12:15], a[232:235], a[184:187], a[12:15]
    buffer_load_dwordx4 v7, s[4:7], s35 offen nt lds
    v_mfma_f32_16x16x32_bf16 a[12:15], a[236:239], a[188:191], a[12:15]
    v_mfma_f32_16x16x32_bf16 a[20:23], a[232:235], a[192:195], a[20:23]
    v_mfma_f32_16x16x32_bf16 a[20:23], a[236:239], a[196:199], a[20:23]
    s_waitcnt lgkmcnt(4)
    v_mfma_f32_16x16x32_bf16 a[24:27], a[240:243], a[176:179], a[24:27]
    ds_read_b128 a[232:235], v5 offset:10240
    v_mfma_f32_16x16x32_bf16 a[24:27], a[244:247], a[180:183], a[24:27]
    ds_read_b128 a[236:239], v6 offset:10240
    v_mfma_f32_16x16x32_bf16 a[32:35], a[240:243], a[184:187], a[32:35]
    buffer_load_dwordx4 v11, s[4:7], s35 offen offset:1024 nt lds
    v_mfma_f32_16x16x32_bf16 a[32:35], a[244:247], a[188:191], a[32:35]
L_pg1:
    s_cbranch_execz L_warm_done1
    v_mfma_f32_16x16x32_bf16 a[40:43], a[240:243], a[192:195], a[40:43]
    v_mfma_f32_16x16x32_bf16 a[40:43], a[244:247], a[196:199], a[40:43]
    s_waitcnt lgkmcnt(4)
    v_mfma_f32_16x16x32_bf16 a[28:31], a[248:251], a[176:179], a[28:31]
    ds_read_b128 a[240:243], v5 offset:12288
    v_mfma_f32_16x16x32_bf16 a[28:31], a[252:255], a[180:183], a[28:31]
    ds_read_b128 a[244:247], v6 offset:12288
    v_mfma_f32_16x16x32_bf16 a[36:39], a[248:251], a[184:187], a[36:39]
    s_add_u32 s42, s26, s96
    v_mfma_f32_16x16x32_bf16 a[36:39], a[252:255], a[188:191], a[36:39]
    s_add_u32 m0, s23, 0x2000
    v_mfma_f32_16x16x32_bf16 a[44:47], a[248:251], a[192:195], a[44:47]
    v_mfma_f32_16x16x32_bf16 a[44:47], a[252:255], a[196:199], a[44:47]
    s_waitcnt lgkmcnt(4)
    buffer_load_dwordx4 v1, s[8:11], s42 offen nt lds
    v_mfma_f32_16x16x32_bf16 a[48:51], a[224:227], a[176:179], a[48:51]
    ds_read_b128 a[248:251], v5 offset:14336
    v_mfma_f32_16x16x32_bf16 a[48:51], a[228:231], a[180:183], a[48:51]
    ds_read_b128 a[252:255], v6 offset:14336
    v_mfma_f32_16x16x32_bf16 a[56:59], a[224:227], a[184:187], a[56:59]
    v_mfma_f32_16x16x32_bf16 a[56:59], a[228:231], a[188:191], a[56:59]
    buffer_load_dwordx4 v2, s[8:11], s42 offen offset:1024 nt lds
    v_mfma_f32_16x16x32_bf16 a[64:67], a[224:227], a[192:195], a[64:67]
    v_mfma_f32_16x16x32_bf16 a[64:67], a[228:231], a[196:199], a[64:67]
    s_waitcnt lgkmcnt(4)
    v_mfma_f32_16x16x32_bf16 a[52:55], a[232:235], a[176:179], a[52:55]
    ds_read_b128 a[224:227], v5 offset:16384
    v_mfma_f32_16x16x32_bf16 a[52:55], a[236:239], a[180:183], a[52:55]
    ds_read_b128 a[228:231], v6 offset:16384
    v_mfma_f32_16x16x32_bf16 a[60:63], a[232:235], a[184:187], a[60:63]
    v_mfma_f32_16x16x32_bf16 a[60:63], a[236:239], a[188:191], a[60:63]
    s_add_u32 m0, s99, 0x1000
    v_mfma_f32_16x16x32_bf16 a[68:71], a[232:235], a[192:195], a[68:71]
    v_mfma_f32_16x16x32_bf16 a[68:71], a[236:239], a[196:199], a[68:71]
    s_waitcnt lgkmcnt(4)
    v_mfma_f32_16x16x32_bf16 a[72:75], a[240:243], a[176:179], a[72:75]
    ds_read_b128 a[232:235], v5 offset:18432
    v_mfma_f32_16x16x32_bf16 a[72:75], a[244:247], a[180:183], a[72:75]
    ds_read_b128 a[236:239], v6 offset:18432
    v_mfma_f32_16x16x32_bf16 a[80:83], a[240:243], a[184:187], a[80:83]
    buffer_load_dwordx4 v7, s[4:7], s36 offen nt lds
    v_mfma_f32_16x16x32_bf16 a[80:83], a[244:247], a[188:191], a[80:83]
    v_mfma_f32_16x16x32_bf16 a[88:91], a[240:243], a[192:195], a[88:91]
    v_mfma_f32_16x16x32_bf16 a[88:91], a[244:247], a[196:199], a[88:91]
    s_waitcnt lgkmcnt(4)
    v_mfma_f32_16x16x32_bf16 a[76:79], a[248:251], a[176:179], a[76:79]
    ds_read_b128 a[240:243], v5 offset:20480
    v_mfma_f32_16x16x32_bf16 a[76:79], a[252:255], a[180:183], a[76:79]
    ds_read_b128 a[244:247], v6 offset:20480
    v_mfma_f32_16x16x32_bf16 a[84:87], a[248:251], a[184:187], a[84:87]
    buffer_load_dwordx4 v11, s[4:7], s36 offen offset:1024 nt lds
    v_mfma_f32_16x16x32_bf16 a[84:87], a[252:255], a[188:191], a[84:87]
    s_add_u32 s42, s26, s97
    v_mfma_f32_16x16x32_bf16 a[92:95], a[248:251], a[192:195], a[92:95]
    s_add_u32 m0, s23, 0x4000
    v_mfma_f32_16x16x32_bf16 a[92:95], a[252:255], a[196:199], a[92:95]
    s_waitcnt lgkmcnt(4)
    v_mfma_f32_16x16x32_bf16 a[96:99], a[224:227], a[176:179], a[96:99]
    ds_read_b128 a[248:251], v5 offset:22528
    v_mfma_f32_16x16x32_bf16 a[96:99], a[228:231], a[180:183], a[96:99]
    ds_read_b128 a[252:255], v6 offset:22528
    v_mfma_f32_16x16x32_bf16 a[104:107], a[224:227], a[184:187], a[104:107]
    buffer_load_dwordx4 v1, s[8:11], s42 offen nt lds
    v_mfma_f32_16x16x32_bf16 a[104:107], a[228:231], a[188:191], a[104:107]
    v_mfma_f32_16x16x32_bf16 a[112:115], a[224:227], a[192:195], a[112:115]
    v_mfma_f32_16x16x32_bf16 a[112:115], a[228:231], a[196:199], a[112:115]
    s_waitcnt lgkmcnt(4)
    v_mfma_f32_16x16x32_bf16 a[100:103], a[232:235], a[176:179], a[100:103]
    ds_read_b128 a[224:227], v5 offset:24576
    v_mfma_f32_16x16x32_bf16 a[100:103], a[236:239], a[180:183], a[100:103]
    ds_read_b128 a[228:231], v6 offset:24576
    v_mfma_f32_16x16x32_bf16 a[108:111], a[232:235], a[184:187], a[108:111]
    buffer_load_dwordx4 v2, s[8:11], s42 offen offset:1024 nt lds
    v_mfma_f32_16x16x32_bf16 a[108:111], a[236:239], a[188:191], a[108:111]
    v_mfma_f32_16x16x32_bf16 a[116:119], a[232:235], a[192:195], a[116:119]
    v_mfma_f32_16x16x32_bf16 a[116:119], a[236:239], a[196:199], a[116:119]
    s_waitcnt lgkmcnt(4)
    v_mfma_f32_16x16x32_bf16 a[120:123], a[240:243], a[176:179], a[120:123]
    ds_read_b128 a[232:235], v5 offset:26624
    v_mfma_f32_16x16x32_bf16 a[120:123], a[244:247], a[180:183], a[120:123]
    ds_read_b128 a[236:239], v6 offset:26624
    v_mfma_f32_16x16x32_bf16 a[128:131], a[240:243], a[184:187], a[128:131]
    v_mfma_f32_16x16x32_bf16 a[128:131], a[244:247], a[188:191], a[128:131]
    v_mfma_f32_16x16x32_bf16 a[136:139], a[240:243], a[192:195], a[136:139]
    v_mfma_f32_16x16x32_bf16 a[136:139], a[244:247], a[196:199], a[136:139]
    s_waitcnt lgkmcnt(4)
    v_mfma_f32_16x16x32_bf16 a[124:127], a[248:251], a[176:179], a[124:127]
    ds_read_b128 a[240:243], v5 offset:28672
    v_mfma_f32_16x16x32_bf16 a[124:127], a[252:255], a[180:183], a[124:127]
    ds_read_b128 a[244:247], v6 offset:28672
    v_mfma_f32_16x16x32_bf16 a[132:135], a[248:251], a[184:187], a[132:135]
    s_add_u32 s42, s26, s98
    v_mfma_f32_16x16x32_bf16 a[132:135], a[252:255], a[188:191], a[132:135]
    s_add_u32 m0, s23, 0x6000
    v_mfma_f32_16x16x32_bf16 a[140:143], a[248:251], a[192:195], a[140:143]
    v_mfma_f32_16x16x32_bf16 a[140:143], a[252:255], a[196:199], a[140:143]
    s_waitcnt lgkmcnt(4)
    buffer_load_dwordx4 v1, s[8:11], s42 offen nt lds
    v_mfma_f32_16x16x32_bf16 a[144:147], a[224:227], a[176:179], a[144:147]
    ds_read_b128 a[248:251], v5 offset:30720
    v_mfma_f32_16x16x32_bf16 a[144:147], a[228:231], a[180:183], a[144:147]
    ds_read_b128 a[252:255], v6 offset:30720
    v_mfma_f32_16x16x32_bf16 v[24:27], a[224:227], a[184:187], v[24:27]
    v_mfma_f32_16x16x32_bf16 v[24:27], a[228:231], a[188:191], v[24:27]
    buffer_load_dwordx4 v2, s[8:11], s42 offen offset:1024 nt lds
    v_mfma_f32_16x16x32_bf16 v[32:35], a[224:227], a[192:195], v[32:35]
    v_mfma_f32_16x16x32_bf16 v[32:35], a[228:231], a[196:199], v[32:35]
    s_waitcnt lgkmcnt(4)
    v_mfma_f32_16x16x32_bf16 a[148:151], a[232:235], a[176:179], a[148:151]
    s_waitcnt vmcnt(14)
    s_barrier
    ds_read_b128 a[224:227], v5 offset:32768
    v_mfma_f32_16x16x32_bf16 a[148:151], a[236:239], a[180:183], a[148:151]
    ds_read_b128 a[228:231], v6 offset:32768
    v_mfma_f32_16x16x32_bf16 v[28:31], a[232:235], a[184:187], v[28:31]
    v_mfma_f32_16x16x32_bf16 v[28:31], a[236:239], a[188:191], v[28:31]
    v_mfma_f32_16x16x32_bf16 v[36:39], a[232:235], a[192:195], v[36:39]
    v_mfma_f32_16x16x32_bf16 v[36:39], a[236:239], a[196:199], v[36:39]
    s_waitcnt lgkmcnt(4)
    v_mfma_f32_16x16x32_bf16 v[40:43], a[240:243], a[176:179], v[40:43]
    ds_read_b128 a[232:235], v5 offset:34816
    v_mfma_f32_16x16x32_bf16 v[40:43], a[244:247], a[180:183], v[40:43]
    ds_read_b128 a[236:239], v6 offset:34816
    v_mfma_f32_16x16x32_bf16 v[48:51], a[240:243], a[184:187], v[48:51]
    v_mfma_f32_16x16x32_bf16 v[48:51], a[244:247], a[188:191], v[48:51]
    v_mfma_f32_16x16x32_bf16 v[56:59], a[240:243], a[192:195], v[56:59]
    v_mfma_f32_16x16x32_bf16 v[56:59], a[244:247], a[196:199], v[56:59]
    s_waitcnt lgkmcnt(4)
    v_mfma_f32_16x16x32_bf16 v[44:47], a[248:251], a[176:179], v[44:47]
    ds_read_b128 a[240:243], v5 offset:36864
    v_mfma_f32_16x16x32_bf16 v[44:47], a[252:255], a[180:183], v[44:47]
    ds_read_b128 a[244:247], v6 offset:36864
    v_mfma_f32_16x16x32_bf16 v[52:55], a[248:251], a[184:187], v[52:55]
    s_add_u32 s42, s27, s43
    v_mfma_f32_16x16x32_bf16 v[52:55], a[252:255], a[188:191], v[52:55]
    s_add_u32 m0, s23, 0x8000
    v_mfma_f32_16x16x32_bf16 v[60:63], a[248:251], a[192:195], v[60:63]
    v_mfma_f32_16x16x32_bf16 v[60:63], a[252:255], a[196:199], v[60:63]
    s_waitcnt lgkmcnt(4)
    buffer_load_dwordx4 v1, s[8:11], s42 offen nt lds
    v_mfma_f32_16x16x32_bf16 v[64:67], a[224:227], a[176:179], v[64:67]
    ds_read_b128 a[248:251], v5 offset:38912
    v_mfma_f32_16x16x32_bf16 v[64:67], a[228:231], a[180:183], v[64:67]
    ds_read_b128 a[252:255], v6 offset:38912
    v_mfma_f32_16x16x32_bf16 v[72:75], a[224:227], a[184:187], v[72:75]
    v_mfma_f32_16x16x32_bf16 v[72:75], a[228:231], a[188:191], v[72:75]
    buffer_load_dwordx4 v2, s[8:11], s42 offen offset:1024 nt lds
    v_mfma_f32_16x16x32_bf16 v[80:83], a[224:227], a[192:195], v[80:83]
    v_mfma_f32_16x16x32_bf16 v[80:83], a[228:231], a[196:199], v[80:83]
    s_waitcnt lgkmcnt(4)
    v_mfma_f32_16x16x32_bf16 v[68:71], a[232:235], a[176:179], v[68:71]
    ds_read_b128 a[224:227], v5 offset:40960
    v_mfma_f32_16x16x32_bf16 v[68:71], a[236:239], a[180:183], v[68:71]
    ds_read_b128 a[228:231], v6 offset:40960
    v_mfma_f32_16x16x32_bf16 v[76:79], a[232:235], a[184:187], v[76:79]
    v_mfma_f32_16x16x32_bf16 v[76:79], a[236:239], a[188:191], v[76:79]
    v_mfma_f32_16x16x32_bf16 v[84:87], a[232:235], a[192:195], v[84:87]
    s_waitcnt vmcnt(14)
    ds_read_b128 a[200:203], v3 offset:0
    v_mfma_f32_16x16x32_bf16 v[84:87], a[236:239], a[196:199], v[84:87]
    s_waitcnt lgkmcnt(5)
    v_mfma_f32_16x16x32_bf16 v[88:91], a[240:243], a[176:179], v[88:91]
    ds_read_b128 a[232:235], v5 offset:43008
    v_mfma_f32_16x16x32_bf16 v[88:91], a[244:247], a[180:183], v[88:91]
    ds_read_b128 a[236:239], v6 offset:43008
    v_mfma_f32_16x16x32_bf16 v[96:99], a[240:243], a[184:187], v[96:99]
    ds_read_b128 a[204:207], v4 offset:0
    v_mfma_f32_16x16x32_bf16 v[96:99], a[244:247], a[188:191], v[96:99]
    v_mfma_f32_16x16x32_bf16 v[104:107], a[240:243], a[192:195], v[104:107]
    v_mfma_f32_16x16x32_bf16 v[104:107], a[244:247], a[196:199], v[104:107]
    s_waitcnt lgkmcnt(6)
    v_mfma_f32_16x16x32_bf16 v[92:95], a[248:251], a[176:179], v[92:95]
    ds_read_b128 a[240:243], v5 offset:45056
    v_mfma_f32_16x16x32_bf16 v[92:95], a[252:255], a[180:183], v[92:95]
    ds_read_b128 a[244:247], v6 offset:45056
    v_mfma_f32_16x16x32_bf16 v[100:103], a[248:251], a[184:187], v[100:103]
    s_add_u32 s42, s27, s96
    v_mfma_f32_16x16x32_bf16 v[100:103], a[252:255], a[188:191], v[100:103]
    s_add_u32 m0, s23, 0xa000
    v_mfma_f32_16x16x32_bf16 v[108:111], a[248:251], a[192:195], v[108:111]
    v_mfma_f32_16x16x32_bf16 v[108:111], a[252:255], a[196:199], v[108:111]
    s_waitcnt lgkmcnt(6)
    buffer_load_dwordx4 v1, s[8:11], s42 offen nt lds
    v_mfma_f32_16x16x32_bf16 v[112:115], a[224:227], a[176:179], v[112:115]
    ds_read_b128 a[248:251], v5 offset:47104
    v_mfma_f32_16x16x32_bf16 v[112:115], a[228:231], a[180:183], v[112:115]
    ds_read_b128 a[252:255], v6 offset:47104
    v_mfma_f32_16x16x32_bf16 v[120:123], a[224:227], a[184:187], v[120:123]
    v_mfma_f32_16x16x32_bf16 v[120:123], a[228:231], a[188:191], v[120:123]
    buffer_load_dwordx4 v2, s[8:11], s42 offen offset:1024 nt lds
    v_mfma_f32_16x16x32_bf16 v[128:131], a[224:227], a[192:195], v[128:131]
    v_mfma_f32_16x16x32_bf16 v[128:131], a[228:231], a[196:199], v[128:131]
    s_waitcnt lgkmcnt(5)
    v_mfma_f32_16x16x32_bf16 v[116:119], a[232:235], a[176:179], v[116:119]
    ds_read_b128 a[224:227], v5 offset:49152
    v_mfma_f32_16x16x32_bf16 v[116:119], a[236:239], a[180:183], v[116:119]
    ds_read_b128 a[228:231], v6 offset:49152
    v_mfma_f32_16x16x32_bf16 v[124:127], a[232:235], a[184:187], v[124:127]
    v_mfma_f32_16x16x32_bf16 v[124:127], a[236:239], a[188:191], v[124:127]
    s_waitcnt vmcnt(12)
    ds_read_b128 a[208:211], v3 offset:2048
    v_mfma_f32_16x16x32_bf16 v[132:135], a[232:235], a[192:195], v[132:135]
    ds_read_b128 a[212:215], v4 offset:2048
    v_mfma_f32_16x16x32_bf16 v[132:135], a[236:239], a[196:199], v[132:135]
    s_waitcnt lgkmcnt(6)
    v_mfma_f32_16x16x32_bf16 v[136:139], a[240:243], a[176:179], v[136:139]
    s_add_u32 m0, s99, 0
    ds_read_b128 a[232:235], v5 offset:51200
    v_mfma_f32_16x16x32_bf16 v[136:139], a[244:247], a[180:183], v[136:139]
    ds_read_b128 a[236:239], v6 offset:51200
    v_mfma_f32_16x16x32_bf16 v[144:147], a[240:243], a[184:187], v[144:147]
    buffer_load_dwordx4 v7, s[4:7], s37 offen nt lds
    v_mfma_f32_16x16x32_bf16 v[144:147], a[244:247], a[188:191], v[144:147]
    v_mfma_f32_16x16x32_bf16 v[152:155], a[240:243], a[192:195], v[152:155]
    v_mfma_f32_16x16x32_bf16 v[152:155], a[244:247], a[196:199], v[152:155]
    s_waitcnt lgkmcnt(6)
    v_mfma_f32_16x16x32_bf16 v[140:143], a[248:251], a[176:179], v[140:143]
    ds_read_b128 a[240:243], v5 offset:53248
    v_mfma_f32_16x16x32_bf16 v[140:143], a[252:255], a[180:183], v[140:143]
    ds_read_b128 a[244:247], v6 offset:53248
    v_mfma_f32_16x16x32_bf16 v[148:151], a[248:251], a[184:187], v[148:151]
    buffer_load_dwordx4 v11, s[4:7], s37 offen offset:1024 nt lds
    v_mfma_f32_16x16x32_bf16 v[148:151], a[252:255], a[188:191], v[148:151]
    s_add_u32 s42, s27, s97
    v_mfma_f32_16x16x32_bf16 v[156:159], a[248:251], a[192:195], v[156:159]
    s_add_u32 m0, s23, 0xc000
    v_mfma_f32_16x16x32_bf16 v[156:159], a[252:255], a[196:199], v[156:159]
    s_waitcnt lgkmcnt(6)
    v_mfma_f32_16x16x32_bf16 v[160:163], a[224:227], a[176:179], v[160:163]
    ds_read_b128 a[248:251], v5 offset:55296
    v_mfma_f32_16x16x32_bf16 v[160:163], a[228:231], a[180:183], v[160:163]
    ds_read_b128 a[252:255], v6 offset:55296
    v_mfma_f32_16x16x32_bf16 v[168:171], a[224:227], a[184:187], v[168:171]
    buffer_load_dwordx4 v1, s[8:11], s42 offen nt lds
    v_mfma_f32_16x16x32_bf16 v[168:171], a[228:231], a[188:191], v[168:171]
    v_mfma_f32_16x16x32_bf16 v[176:179], a[224:227], a[192:195], v[176:179]
    v_mfma_f32_16x16x32_bf16 v[176:179], a[228:231], a[196:199], v[176:179]
    s_waitcnt lgkmcnt(4)
    v_mfma_f32_16x16x32_bf16 v[164:167], a[232:235], a[176:179], v[164:167]
    ds_read_b128 a[224:227], v5 offset:57344
    v_mfma_f32_16x16x32_bf16 v[164:167], a[236:239], a[180:183], v[164:167]
    ds_read_b128 a[228:231], v6 offset:57344
    v_mfma_f32_16x16x32_bf16 v[172:175], a[232:235], a[184:187], v[172:175]
    buffer_load_dwordx4 v2, s[8:11], s42 offen offset:1024 nt lds
    v_mfma_f32_16x16x32_bf16 v[172:175], a[236:239], a[188:191], v[172:175]
    s_add_u32 m0, s99, 0x800
    v_mfma_f32_16x16x32_bf16 v[180:183], a[232:235], a[192:195], v[180:183]
    v_mfma_f32_16x16x32_bf16 v[180:183], a[236:239], a[196:199], v[180:183]
    s_waitcnt lgkmcnt(4)
    v_mfma_f32_16x16x32_bf16 v[184:187], a[240:243], a[176:179], v[184:187]
    ds_read_b128 a[232:235], v5 offset:59392
    v_mfma_f32_16x16x32_bf16 v[184:187], a[244:247], a[180:183], v[184:187]
    ds_read_b128 a[236:239], v6 offset:59392
    v_mfma_f32_16x16x32_bf16 v[192:195], a[240:243], a[184:187], v[192:195]
    buffer_load_dwordx4 v7, s[4:7], s38 offen nt lds
    v_mfma_f32_16x16x32_bf16 v[192:195], a[244:247], a[188:191], v[192:195]
    s_waitcnt vmcnt(13)
    ds_read_b128 a[216:219], v3 offset:4096
    v_mfma_f32_16x16x32_bf16 v[200:203], a[240:243], a[192:195], v[200:203]
    ds_read_b128 a[220:223], v4 offset:4096
    v_mfma_f32_16x16x32_bf16 v[200:203], a[244:247], a[196:199], v[200:203]
    s_waitcnt lgkmcnt(6)
    v_mfma_f32_16x16x32_bf16 v[188:191], a[248:251], a[176:179], v[188:191]
    ds_read_b128 a[240:243], v5 offset:61440
    v_mfma_f32_16x16x32_bf16 v[188:191], a[252:255], a[180:183], v[188:191]
    ds_read_b128 a[244:247], v6 offset:61440
    v_mfma_f32_16x16x32_bf16 v[196:199], a[248:251], a[184:187], v[196:199]
    buffer_load_dwordx4 v11, s[4:7], s38 offen offset:1024 nt lds
    v_mfma_f32_16x16x32_bf16 v[196:199], a[252:255], a[188:191], v[196:199]
    s_add_u32 s42, s27, s98
    v_mfma_f32_16x16x32_bf16 v[204:207], a[248:251], a[192:195], v[204:207]
    s_add_u32 m0, s23, 0xe000
    v_mfma_f32_16x16x32_bf16 v[204:207], a[252:255], a[196:199], v[204:207]
    s_waitcnt lgkmcnt(6)
    v_mfma_f32_16x16x32_bf16 v[208:211], a[224:227], a[176:179], v[208:211]
    ds_read_b128 a[248:251], v5 offset:63488
    v_mfma_f32_16x16x32_bf16 v[208:211], a[228:231], a[180:183], v[208:211]
    ds_read_b128 a[252:255], v6 offset:63488
    v_mfma_f32_16x16x32_bf16 v[216:219], a[224:227], a[184:187], v[216:219]
    buffer_load_dwordx4 v1, s[8:11], s42 offen nt lds
    v_mfma_f32_16x16x32_bf16 v[216:219], a[228:231], a[188:191], v[216:219]
    v_mfma_f32_16x16x32_bf16 v[224:227], a[224:227], a[192:195], v[224:227]
    v_mfma_f32_16x16x32_bf16 v[224:227], a[228:231], a[196:199], v[224:227]
    s_waitcnt lgkmcnt(6)
    v_mfma_f32_16x16x32_bf16 v[212:215], a[232:235], a[176:179], v[212:215]
    s_waitcnt vmcnt(11)
    s_barrier
    buffer_load_dwordx4 v2, s[8:11], s42 offen offset:1024 nt lds
    v_mfma_f32_16x16x32_bf16 v[212:215], a[236:239], a[180:183], v[212:215]
    v_subrev_u32 v5, 0x10000, v5
    v_subrev_u32 v6, 0x10000, v6
    v_mfma_f32_16x16x32_bf16 v[220:223], a[232:235], a[184:187], v[220:223]
    ds_read_b128 a[224:227], v5 offset:0
    v_mfma_f32_16x16x32_bf16 v[220:223], a[236:239], a[188:191], v[220:223]
    ds_read_b128 a[228:231], v6 offset:0
    v_mfma_f32_16x16x32_bf16 v[228:231], a[232:235], a[192:195], v[228:231]
    v_mfma_f32_16x16x32_bf16 v[228:231], a[236:239], a[196:199], v[228:231]
    s_waitcnt lgkmcnt(4)
    v_mfma_f32_16x16x32_bf16 v[232:235], a[240:243], a[176:179], v[232:235]
    s_add_u32 m0, s99, 0x1000
    ds_read_b128 a[232:235], v5 offset:2048
    v_mfma_f32_16x16x32_bf16 v[232:235], a[244:247], a[180:183], v[232:235]
    ds_read_b128 a[236:239], v6 offset:2048
    v_mfma_f32_16x16x32_bf16 v[240:243], a[240:243], a[184:187], v[240:243]
    buffer_load_dwordx4 v7, s[4:7], s39 offen nt lds
    v_mfma_f32_16x16x32_bf16 v[240:243], a[244:247], a[188:191], v[240:243]
    v_mfma_f32_16x16x32_bf16 v[248:251], a[240:243], a[192:195], v[248:251]
    v_mfma_f32_16x16x32_bf16 v[248:251], a[244:247], a[196:199], v[248:251]
    s_waitcnt lgkmcnt(4)
    v_mfma_f32_16x16x32_bf16 v[236:239], a[248:251], a[176:179], v[236:239]
    ds_read_b128 a[240:243], v5 offset:4096
    v_mfma_f32_16x16x32_bf16 v[236:239], a[252:255], a[180:183], v[236:239]
    ds_read_b128 a[244:247], v6 offset:4096
    v_mfma_f32_16x16x32_bf16 v[244:247], a[248:251], a[184:187], v[244:247]
    buffer_load_dwordx4 v11, s[4:7], s39 offen offset:1024 nt lds
    v_mfma_f32_16x16x32_bf16 v[244:247], a[252:255], a[188:191], v[244:247]
    s_add_u32 s42, s26, s43
    v_mfma_f32_16x16x32_bf16 v[252:255], a[248:251], a[192:195], v[252:255]
    s_add_u32 s42, s42, 0x20000
    v_mfma_f32_16x16x32_bf16 v[252:255], a[252:255], a[196:199], v[252:255]
    s_waitcnt lgkmcnt(4)
    v_mfma_f32_16x16x32_bf16 a[0:3], a[224:227], a[200:203], a[0:3]
    s_add_u32 m0, s23, 0x10000
    ds_read_b128 a[248:251], v5 offset:6144
    v_mfma_f32_16x16x32_bf16 a[0:3], a[228:231], a[204:207], a[0:3]
    ds_read_b128 a[252:255], v6 offset:6144
    v_mfma_f32_16x16x32_bf16 a[8:11], a[224:227], a[208:211], a[8:11]
    buffer_load_dwordx4 v1, s[8:11], s42 offen nt lds
    v_mfma_f32_16x16x32_bf16 a[8:11], a[228:231], a[212:215], a[8:11]
    v_mfma_f32_16x16x32_bf16 a[16:19], a[224:227], a[216:219], a[16:19]
    v_mfma_f32_16x16x32_bf16 a[16:19], a[228:231], a[220:223], a[16:19]
    s_waitcnt lgkmcnt(4)
    v_mfma_f32_16x16x32_bf16 a[4:7], a[232:235], a[200:203], a[4:7]
    ds_read_b128 a[224:227], v5 offset:8192
    v_mfma_f32_16x16x32_bf16 a[4:7], a[236:239], a[204:207], a[4:7]
    ds_read_b128 a[228:231], v6 offset:8192
    v_mfma_f32_16x16x32_bf16 a[12:15], a[232:235], a[208:211], a[12:15]
    buffer_load_dwordx4 v2, s[8:11], s42 offen offset:1024 nt lds
    v_mfma_f32_16x16x32_bf16 a[12:15], a[236:239], a[212:215], a[12:15]
    v_mfma_f32_16x16x32_bf16 a[20:23], a[232:235], a[216:219], a[20:23]
    v_mfma_f32_16x16x32_bf16 a[20:23], a[236:239], a[220:223], a[20:23]
    s_waitcnt lgkmcnt(4)
    v_mfma_f32_16x16x32_bf16 a[24:27], a[240:243], a[200:203], a[24:27]
    ds_read_b128 a[232:235], v5 offset:10240
    v_mfma_f32_16x16x32_bf16 a[24:27], a[244:247], a[204:207], a[24:27]
    ds_read_b128 a[236:239], v6 offset:10240
    v_mfma_f32_16x16x32_bf16 a[32:35], a[240:243], a[208:211], a[32:35]
    v_mfma_f32_16x16x32_bf16 a[32:35], a[244:247], a[212:215], a[32:35]
    v_mfma_f32_16x16x32_bf16 a[40:43], a[240:243], a[216:219], a[40:43]
    v_mfma_f32_16x16x32_bf16 a[40:43], a[244:247], a[220:223], a[40:43]
    s_waitcnt lgkmcnt(4)
    v_mfma_f32_16x16x32_bf16 a[28:31], a[248:251], a[200:203], a[28:31]
    ds_read_b128 a[240:243], v5 offset:12288
    v_mfma_f32_16x16x32_bf16 a[28:31], a[252:255], a[204:207], a[28:31]
    ds_read_b128 a[244:247], v6 offset:12288
    v_mfma_f32_16x16x32_bf16 a[36:39], a[248:251], a[208:211], a[36:39]
    s_add_u32 s42, s26, s96
    v_mfma_f32_16x16x32_bf16 a[36:39], a[252:255], a[212:215], a[36:39]
    s_add_u32 s42, s42, 0x20000
    v_mfma_f32_16x16x32_bf16 a[44:47], a[248:251], a[216:219], a[44:47]
    s_add_u32 m0, s23, 0x12000
    v_mfma_f32_16x16x32_bf16 a[44:47], a[252:255], a[220:223], a[44:47]
    s_waitcnt lgkmcnt(4)
    buffer_load_dwordx4 v1, s[8:11], s42 offen nt lds
    v_mfma_f32_16x16x32_bf16 a[48:51], a[224:227], a[200:203], a[48:51]
    ds_read_b128 a[248:251], v5 offset:14336
    v_mfma_f32_16x16x32_bf16 a[48:51], a[228:231], a[204:207], a[48:51]
    ds_read_b128 a[252:255], v6 offset:14336
    v_mfma_f32_16x16x32_bf16 a[56:59], a[224:227], a[208:211], a[56:59]
    v_mfma_f32_16x16x32_bf16 a[56:59], a[228:231], a[212:215], a[56:59]
    buffer_load_dwordx4 v2, s[8:11], s42 offen offset:1024 nt lds
    v_mfma_f32_16x16x32_bf16 a[64:67], a[224:227], a[216:219], a[64:67]
    v_mfma_f32_16x16x32_bf16 a[64:67], a[228:231], a[220:223], a[64:67]
    s_waitcnt lgkmcnt(4)
    v_mfma_f32_16x16x32_bf16 a[52:55], a[232:235], a[200:203], a[52:55]
    ds_read_b128 a[224:227], v5 offset:16384
    v_mfma_f32_16x16x32_bf16 a[52:55], a[236:239], a[204:207], a[52:55]
    ds_read_b128 a[228:231], v6 offset:16384
    v_mfma_f32_16x16x32_bf16 a[60:63], a[232:235], a[208:211], a[60:63]
    v_mfma_f32_16x16x32_bf16 a[60:63], a[236:239], a[212:215], a[60:63]
    v_mfma_f32_16x16x32_bf16 a[68:71], a[232:235], a[216:219], a[68:71]
    v_mfma_f32_16x16x32_bf16 a[68:71], a[236:239], a[220:223], a[68:71]
    s_waitcnt lgkmcnt(4)
    v_mfma_f32_16x16x32_bf16 a[72:75], a[240:243], a[200:203], a[72:75]
    ds_read_b128 a[232:235], v5 offset:18432
    v_mfma_f32_16x16x32_bf16 a[72:75], a[244:247], a[204:207], a[72:75]
    ds_read_b128 a[236:239], v6 offset:18432
    v_mfma_f32_16x16x32_bf16 a[80:83], a[240:243], a[208:211], a[80:83]
    v_mfma_f32_16x16x32_bf16 a[80:83], a[244:247], a[212:215], a[80:83]
    v_mfma_f32_16x16x32_bf16 a[88:91], a[240:243], a[216:219], a[88:91]
    v_mfma_f32_16x16x32_bf16 a[88:91], a[244:247], a[220:223], a[88:91]
    s_waitcnt lgkmcnt(4)
    v_mfma_f32_16x16x32_bf16 a[76:79], a[248:251], a[200:203], a[76:79]
    ds_read_b128 a[240:243], v5 offset:20480
    v_mfma_f32_16x16x32_bf16 a[76:79], a[252:255], a[204:207], a[76:79]
    ds_read_b128 a[244:247], v6 offset:20480
    v_mfma_f32_16x16x32_bf16 a[84:87], a[248:251], a[208:211], a[84:87]
    s_add_u32 s42, s26, s97
    v_mfma_f32_16x16x32_bf16 a[84:87], a[252:255], a[212:215], a[84:87]
    s_add_u32 s42, s42, 0x20000
    v_mfma_f32_16x16x32_bf16 a[92:95], a[248:251], a[216:219], a[92:95]
    s_add_u32 m0, s23, 0x14000
    v_mfma_f32_16x16x32_bf16 a[92:95], a[252:255], a[220:223], a[92:95]
    s_waitcnt lgkmcnt(4)
    buffer_load_dwordx4 v1, s[8:11], s42 offen nt lds
    v_mfma_f32_16x16x32_bf16 a[96:99], a[224:227], a[200:203], a[96:99]
    ds_read_b128 a[248:251], v5 offset:22528
    v_mfma_f32_16x16x32_bf16 a[96:99], a[228:231], a[204:207], a[96:99]
    ds_read_b128 a[252:255], v6 offset:22528
    v_mfma_f32_16x16x32_bf16 a[104:107], a[224:227], a[208:211], a[104:107]
    v_mfma_f32_16x16x32_bf16 a[104:107], a[228:231], a[212:215], a[104:107]
    buffer_load_dwordx4 v2, s[8:11], s42 offen offset:1024 nt lds
    v_mfma_f32_16x16x32_bf16 a[112:115], a[224:227], a[216:219], a[112:115]
    v_mfma_f32_16x16x32_bf16 a[112:115], a[228:231], a[220:223], a[112:115]
    s_waitcnt lgkmcnt(4)
    v_mfma_f32_16x16x32_bf16 a[100:103], a[232:235], a[200:203], a[100:103]
    ds_read_b128 a[224:227], v5 offset:24576
    v_mfma_f32_16x16x32_bf16 a[100:103], a[236:239], a[204:207], a[100:103]
    ds_read_b128 a[228:231], v6 offset:24576
    v_mfma_f32_16x16x32_bf16 a[108:111], a[232:235], a[208:211], a[108:111]
    v_mfma_f32_16x16x32_bf16 a[108:111], a[236:239], a[212:215], a[108:111]
    v_mfma_f32_16x16x32_bf16 a[116:119], a[232:235], a[216:219], a[116:119]
    v_mfma_f32_16x16x32_bf16 a[116:119], a[236:239], a[220:223], a[116:119]
    s_waitcnt lgkmcnt(4)
    v_mfma_f32_16x16x32_bf16 a[120:123], a[240:243], a[200:203], a[120:123]
    ds_read_b128 a[232:235], v5 offset:26624
    v_mfma_f32_16x16x32_bf16 a[120:123], a[244:247], a[204:207], a[120:123]
    ds_read_b128 a[236:239], v6 offset:26624
    v_mfma_f32_16x16x32_bf16 a[128:131], a[240:243], a[208:211], a[128:131]
    v_mfma_f32_16x16x32_bf16 a[128:131], a[244:247], a[212:215], a[128:131]
    s_waitcnt vmcnt(14)
    ds_read_b128 a[152:155], v3 offset:0
    v_mfma_f32_16x16x32_bf16 a[136:139], a[240:243], a[216:219], a[136:139]
    ds_read_b128 a[156:159], v4 offset:0
    v_mfma_f32_16x16x32_bf16 a[136:139], a[244:247], a[220:223], a[136:139]
    s_waitcnt lgkmcnt(6)
    v_mfma_f32_16x16x32_bf16 a[124:127], a[248:251], a[200:203], a[124:127]
    ds_read_b128 a[240:243], v5 offset:28672
    v_mfma_f32_16x16x32_bf16 a[124:127], a[252:255], a[204:207], a[124:127]
    ds_read_b128 a[244:247], v6 offset:28672
    v_mfma_f32_16x16x32_bf16 a[132:135], a[248:251], a[208:211], a[132:135]
    s_add_u32 s42, s26, s98
    v_mfma_f32_16x16x32_bf16 a[132:135], a[252:255], a[212:215], a[132:135]
    s_add_u32 s42, s42, 0x20000
    v_mfma_f32_16x16x32_bf16 a[140:143], a[248:251], a[216:219], a[140:143]
    s_add_u32 m0, s23, 0x16000
    v_mfma_f32_16x16x32_bf16 a[140:143], a[252:255], a[220:223], a[140:143]
    s_waitcnt lgkmcnt(6)
    buffer_load_dwordx4 v1, s[8:11], s42 offen nt lds
    v_mfma_f32_16x16x32_bf16 a[144:147], a[224:227], a[200:203], a[144:147]
    ds_read_b128 a[248:251], v5 offset:30720
    v_mfma_f32_16x16x32_bf16 a[144:147], a[228:231], a[204:207], a[144:147]
    ds_read_b128 a[252:255], v6 offset:30720
    v_mfma_f32_16x16x32_bf16 v[24:27], a[224:227], a[208:211], v[24:27]
    v_mfma_f32_16x16x32_bf16 v[24:27], a[228:231], a[212:215], v[24:27]
    s_waitcnt vmcnt(11)
    ds_read_b128 a[160:163], v3 offset:2048
    v_mfma_f32_16x16x32_bf16 v[32:35], a[224:227], a[216:219], v[32:35]
    ds_read_b128 a[164:167], v4 offset:2048
    v_mfma_f32_16x16x32_bf16 v[32:35], a[228:231], a[220:223], v[32:35]
    s_waitcnt lgkmcnt(8)
    buffer_load_dwordx4 v2, s[8:11], s42 offen offset:1024 nt lds
    v_mfma_f32_16x16x32_bf16 a[148:151], a[232:235], a[200:203], a[148:151]
    s_waitcnt vmcnt(10)
    s_barrier
    ds_read_b128 a[224:227], v5 offset:32768
    v_mfma_f32_16x16x32_bf16 a[148:151], a[236:239], a[204:207], a[148:151]
    ds_read_b128 a[228:231], v6 offset:32768
    v_mfma_f32_16x16x32_bf16 v[28:31], a[232:235], a[208:211], v[28:31]
    s_waitcnt vmcnt(8)
    ds_read_b128 a[168:171], v3 offset:4096
    v_mfma_f32_16x16x32_bf16 v[28:31], a[236:239], a[212:215], v[28:31]
    ds_read_b128 a[172:175], v4 offset:4096
    v_mfma_f32_16x16x32_bf16 v[36:39], a[232:235], a[216:219], v[36:39]
    v_mfma_f32_16x16x32_bf16 v[36:39], a[236:239], a[220:223], v[36:39]
    s_waitcnt lgkmcnt(8)
    v_mfma_f32_16x16x32_bf16 v[40:43], a[240:243], a[200:203], v[40:43]
    ds_read_b128 a[232:235], v5 offset:34816
    v_mfma_f32_16x16x32_bf16 v[40:43], a[244:247], a[204:207], v[40:43]
    ds_read_b128 a[236:239], v6 offset:34816
    v_mfma_f32_16x16x32_bf16 v[48:51], a[240:243], a[208:211], v[48:51]
    v_mfma_f32_16x16x32_bf16 v[48:51], a[244:247], a[212:215], v[48:51]
    v_mfma_f32_16x16x32_bf16 v[56:59], a[240:243], a[216:219], v[56:59]
    v_mfma_f32_16x16x32_bf16 v[56:59], a[244:247], a[220:223], v[56:59]
    s_waitcnt lgkmcnt(8)
    v_mfma_f32_16x16x32_bf16 v[44:47], a[248:251], a[200:203], v[44:47]
    ds_read_b128 a[240:243], v5 offset:36864
    v_mfma_f32_16x16x32_bf16 v[44:47], a[252:255], a[204:207], v[44:47]
    ds_read_b128 a[244:247], v6 offset:36864
    v_mfma_f32_16x16x32_bf16 v[52:55], a[248:251], a[208:211], v[52:55]
    s_add_u32 s42, s27, s43
    v_mfma_f32_16x16x32_bf16 v[52:55], a[252:255], a[212:215], v[52:55]
    s_add_u32 s42, s42, 0x20000
    v_mfma_f32_16x16x32_bf16 v[60:63], a[248:251], a[216:219], v[60:63]
    s_add_u32 m0, s23, 0x18000
    v_mfma_f32_16x16x32_bf16 v[60:63], a[252:255], a[220:223], v[60:63]
    s_waitcnt lgkmcnt(6)
    buffer_load_dwordx4 v1, s[8:11], s42 offen nt lds
    v_mfma_f32_16x16x32_bf16 a[0:3], a[224:227], a[152:155], a[0:3]
    ds_read_b128 a[248:251], v5 offset:38912
    v_mfma_f32_16x16x32_bf16 a[0:3], a[228:231], a[156:159], a[0:3]
    ds_read_b128 a[252:255], v6 offset:38912
    v_mfma_f32_16x16x32_bf16 a[8:11], a[224:227], a[160:163], a[8:11]
    v_mfma_f32_16x16x32_bf16 a[8:11], a[228:231], a[164:167], a[8:11]
    s_waitcnt lgkmcnt(6)
    buffer_load_dwordx4 v2, s[8:11], s42 offen offset:1024 nt lds
    v_mfma_f32_16x16x32_bf16 a[16:19], a[224:227], a[168:171], a[16:19]
    v_mfma_f32_16x16x32_bf16 a[16:19], a[228:231], a[172:175], a[16:19]
    s_waitcnt lgkmcnt(4)
    v_mfma_f32_16x16x32_bf16 a[4:7], a[232:235], a[152:155], a[4:7]
    ds_read_b128 a[224:227], v5 offset:40960
    v_accvgpr_read_b32 v18, a0
    v_mfma_f32_16x16x32_bf16 a[4:7], a[236:239], a[156:159], a[4:7]
    ds_read_b128 a[228:231], v6 offset:40960
    v_accvgpr_read_b32 v19, a1
    v_mfma_f32_16x16x32_bf16 a[12:15], a[232:235], a[160:163], a[12:15]
    v_accvgpr_read_b32 v20, a2
    v_accvgpr_read_b32 v21, a3
    v_mfma_f32_16x16x32_bf16 a[12:15], a[236:239], a[164:167], a[12:15]
    v_max3_f32 v8, v8, v18, v19
    v_max3_f32 v8, v8, v20, v21
    v_mfma_f32_16x16x32_bf16 a[20:23], a[232:235], a[168:171], a[20:23]
    v_accvgpr_read_b32 v18, a8
    v_accvgpr_read_b32 v19, a9
    v_mfma_f32_16x16x32_bf16 a[20:23], a[236:239], a[172:175], a[20:23]
    s_waitcnt lgkmcnt(4)
    v_accvgpr_read_b32 v20, a10
    v_accvgpr_read_b32 v21, a11
    v_mfma_f32_16x16x32_bf16 a[24:27], a[240:243], a[152:155], a[24:27]
    ds_read_b128 a[232:235], v5 offset:43008
    v_max3_f32 v9, v9, v18, v19
    v_mfma_f32_16x16x32_bf16 a[24:27], a[244:247], a[156:159], a[24:27]
    ds_read_b128 a[236:239], v6 offset:43008
    v_max3_f32 v9, v9, v20, v21
    v_mfma_f32_16x16x32_bf16 a[32:35], a[240:243], a[160:163], a[32:35]
    v_accvgpr_read_b32 v18, a16
    v_accvgpr_read_b32 v19, a17
    v_mfma_f32_16x16x32_bf16 a[32:35], a[244:247], a[164:167], a[32:35]
    v_accvgpr_read_b32 v20, a18
    v_accvgpr_read_b32 v21, a19
    v_mfma_f32_16x16x32_bf16 a[40:43], a[240:243], a[168:171], a[40:43]
    v_max3_f32 v10, v10, v18, v19
    v_max3_f32 v10, v10, v20, v21
    v_mfma_f32_16x16x32_bf16 a[40:43], a[244:247], a[172:175], a[40:43]
    s_waitcnt lgkmcnt(4)
    v_accvgpr_read_b32 v18, a4
    v_accvgpr_read_b32 v19, a5
    v_mfma_f32_16x16x32_bf16 a[28:31], a[248:251], a[152:155], a[28:31]
    ds_read_b128 a[240:243], v5 offset:45056
L_pg2:
    s_cbranch_execz L_warm_done1
    v_accvgpr_read_b32 v20, a6
    v_mfma_f32_16x16x32_bf16 a[28:31], a[252:255], a[156:159], a[28:31]
    ds_read_b128 a[244:247], v6 offset:45056
    v_accvgpr_read_b32 v21, a7
    v_mfma_f32_16x16x32_bf16 a[36:39], a[248:251], a[160:163], a[36:39]
    s_add_u32 s42, s27, s96
    v_max3_f32 v8, v8, v18, v19
    v_max3_f32 v8, v8, v20, v21
    v_mfma_f32_16x16x32_bf16 a[36:39], a[252:255], a[164:167], a[36:39]
    s_add_u32 s42, s42, 0x20000
    v_accvgpr_read_b32 v18, a12
    v_accvgpr_read_b32 v19, a13
    v_mfma_f32_16x16x32_bf16 a[44:47], a[248:251], a[168:171], a[44:47]
    s_add_u32 m0, s23, 0x1a000
    v_accvgpr_read_b32 v20, a14
    v_accvgpr_read_b32 v21, a15
    v_mfma_f32_16x16x32_bf16 a[44:47], a[252:255], a[172:175], a[44:47]
    s_waitcnt lgkmcnt(4)
    buffer_load_dwordx4 v1, s[8:11], s42 offen nt lds
    v_max3_f32 v9, v9, v18, v19
    v_mfma_f32_16x16x32_bf16 a[48:51], a[224:227], a[152:155], a[48:51]
    ds_read_b128 a[248:251], v5 offset:47104
    v_max3_f32 v9, v9, v20, v21
    v_mfma_f32_16x16x32_bf16 a[48:51], a[228:231], a[156:159], a[48:51]
    ds_read_b128 a[252:255], v6 offset:47104
    v_accvgpr_read_b32 v18, a20
    v_mfma_f32_16x16x32_bf16 a[56:59], a[224:227], a[160:163], a[56:59]
    v_accvgpr_read_b32 v19, a21
    v_accvgpr_read_b32 v20, a22
    v_mfma_f32_16x16x32_bf16 a[56:59], a[228:231], a[164:167], a[56:59]
    buffer_load_dwordx4 v2, s[8:11], s42 offen offset:1024 nt lds
    v_accvgpr_read_b32 v21, a23
    v_mfma_f32_16x16x32_bf16 a[64:67], a[224:227], a[168:171], a[64:67]
    v_max3_f32 v10, v10, v18, v19
    v_max3_f32 v10, v10, v20, v21
    v_mfma_f32_16x16x32_bf16 a[64:67], a[228:231], a[172:175], a[64:67]
    s_waitcnt lgkmcnt(4)
    v_accvgpr_read_b32 v18, a24
    v_accvgpr_read_b32 v19, a25
    v_mfma_f32_16x16x32_bf16 a[52:55], a[232:235], a[152:155], a[52:55]
    ds_read_b128 a[224:227], v5 offset:49152
    v_accvgpr_read_b32 v20, a26
    v_mfma_f32_16x16x32_bf16 a[52:55], a[236:239], a[156:159], a[52:55]
    ds_read_b128 a[228:231], v6 offset:49152
    v_accvgpr_read_b32 v21, a27
    v_mfma_f32_16x16x32_bf16 a[60:63], a[232:235], a[160:163], a[60:63]
    v_max3_f32 v8, v8, v18, v19
    v_max3_f32 v8, v8, v20, v21
    v_mfma_f32_16x16x32_bf16 a[60:63], a[236:239], a[164:167], a[60:63]
    v_accvgpr_read_b32 v18, a32
    v_accvgpr_read_b32 v19, a33
    v_mfma_f32_16x16x32_bf16 a[68:71], a[232:235], a[168:171], a[68:71]
    v_accvgpr_read_b32 v20, a34
    v_accvgpr_read_b32 v21, a35
    v_mfma_f32_16x16x32_bf16 a[68:71], a[236:239], a[172:175], a[68:71]
    s_waitcnt lgkmcnt(4)
    v_max3_f32 v9, v9, v18, v19
    v_max3_f32 v9, v9, v20, v21
    v_mfma_f32_16x16x32_bf16 a[72:75], a[240:243], a[152:155], a[72:75]
    ds_read_b128 a[232:235], v5 offset:51200
    v_accvgpr_read_b32 v18, a40
    v_mfma_f32_16x16x32_bf16 a[72:75], a[244:247], a[156:159], a[72:75]
    ds_read_b128 a[236:239], v6 offset:51200
    v_accvgpr_read_b32 v19, a41
    v_mfma_f32_16x16x32_bf16 a[80:83], a[240:243], a[160:163], a[80:83]
    v_accvgpr_read_b32 v20, a42
    v_accvgpr_read_b32 v21, a43
    v_mfma_f32_16x16x32_bf16 a[80:83], a[244:247], a[164:167], a[80:83]
    v_max3_f32 v10, v10, v18, v19
    v_max3_f32 v10, v10, v20, v21
    v_mfma_f32_16x16x32_bf16 a[88:91], a[240:243], a[168:171], a[88:91]
    v_accvgpr_read_b32 v18, a28
    v_accvgpr_read_b32 v19, a29
    v_mfma_f32_16x16x32_bf16 a[88:91], a[244:247], a[172:175], a[88:91]
    s_waitcnt lgkmcnt(4)
    v_accvgpr_read_b32 v20, a30
    v_accvgpr_read_b32 v21, a31
    v_mfma_f32_16x16x32_bf16 a[76:79], a[248:251], a[152:155], a[76:79]
    ds_read_b128 a[240:243], v5 offset:53248
    v_max3_f32 v8, v8, v18, v19
    v_mfma_f32_16x16x32_bf16 a[76:79], a[252:255], a[156:159], a[76:79]
    ds_read_b128 a[244:247], v6 offset:53248
    v_max3_f32 v8, v8, v20, v21
    v_mfma_f32_16x16x32_bf16 a[84:87], a[248:251], a[160:163], a[84:87]
    s_add_u32 s42, s27, s97
    v_accvgpr_read_b32 v18, a36
    v_accvgpr_read_b32 v19, a37
    v_mfma_f32_16x16x32_bf16 a[84:87], a[252:255], a[164:167], a[84:87]
    s_add_u32 s42, s42, 0x20000
    v_accvgpr_read_b32 v20, a38
    v_accvgpr_read_b32 v21, a39
    v_mfma_f32_16x16x32_bf16 a[92:95], a[248:251], a[168:171], a[92:95]
    s_add_u32 m0, s23, 0x1c000
    v_max3_f32 v9, v9, v18, v19
    v_max3_f32 v9, v9, v20, v21
    v_mfma_f32_16x16x32_bf16 a[92:95], a[252:255], a[172:175], a[92:95]
    s_waitcnt lgkmcnt(4)
    buffer_load_dwordx4 v1, s[8:11], s42 offen nt lds
    v_accvgpr_read_b32 v18, a44
    v_mfma_f32_16x16x32_bf16 a[96:99], a[224:227], a[152:155], a[96:99]
    ds_read_b128 a[248:251], v5 offset:55296
    v_accvgpr_read_b32 v19, a45
    v_mfma_f32_16x16x32_bf16 a[96:99], a[228:231], a[156:159], a[96:99]
    ds_read_b128 a[252:255], v6 offset:55296
    v_accvgpr_read_b32 v20, a46
    v_mfma_f32_16x16x32_bf16 a[104:107], a[224:227], a[160:163], a[104:107]
    v_accvgpr_read_b32 v21, a47
    v_max3_f32 v10, v10, v18, v19
    v_mfma_f32_16x16x32_bf16 a[104:107], a[228:231], a[164:167], a[104:107]
    buffer_load_dwordx4 v2, s[8:11], s42 offen offset:1024 nt lds
    v_max3_f32 v10, v10, v20, v21
    v_mfma_f32_16x16x32_bf16 a[112:115], a[224:227], a[168:171], a[112:115]
    v_accvgpr_read_b32 v18, a48
    v_accvgpr_read_b32 v19, a49
    v_mfma_f32_16x16x32_bf16 a[112:115], a[228:231], a[172:175], a[112:115]
    s_waitcnt lgkmcnt(4)
    v_accvgpr_read_b32 v20, a50
    v_accvgpr_read_b32 v21, a51
    v_mfma_f32_16x16x32_bf16 a[100:103], a[232:235], a[152:155], a[100:103]
    ds_read_b128 a[224:227], v5 offset:57344
    v_max3_f32 v8, v8, v18, v19
    v_mfma_f32_16x16x32_bf16 a[100:103], a[236:239], a[156:159], a[100:103]
    ds_read_b128 a[228:231], v6 offset:57344
    v_max3_f32 v8, v8, v20, v21
    v_mfma_f32_16x16x32_bf16 a[108:111], a[232:235], a[160:163], a[108:111]
    v_accvgpr_read_b32 v18, a56
    v_accvgpr_read_b32 v19, a57
    v_mfma_f32_16x16x32_bf16 a[108:111], a[236:239], a[164:167], a[108:111]
    v_accvgpr_read_b32 v20, a58
    v_accvgpr_read_b32 v21, a59
    v_mfma_f32_16x16x32_bf16 a[116:119], a[232:235], a[168:171], a[116:119]
    v_max3_f32 v9, v9, v18, v19
    v_max3_f32 v9, v9, v20, v21
    v_mfma_f32_16x16x32_bf16 a[116:119], a[236:239], a[172:175], a[116:119]
    s_waitcnt lgkmcnt(4)
    v_accvgpr_read_b32 v18, a64
    v_accvgpr_read_b32 v19, a65
    v_mfma_f32_16x16x32_bf16 a[120:123], a[240:243], a[152:155], a[120:123]
    ds_read_b128 a[232:235], v5 offset:59392
    v_accvgpr_read_b32 v20, a66
    v_mfma_f32_16x16x32_bf16 a[120:123], a[244:247], a[156:159], a[120:123]
    ds_read_b128 a[236:239], v6 offset:59392
    v_accvgpr_read_b32 v21, a67
    v_mfma_f32_16x16x32_bf16 a[128:131], a[240:243], a[160:163], a[128:131]
    v_max3_f32 v10, v10, v18, v19
    v_max3_f32 v10, v10, v20, v21
    v_mfma_f32_16x16x32_bf16 a[128:131], a[244:247], a[164:167], a[128:131]
    v_accvgpr_read_b32 v18, a52
    v_accvgpr_read_b32 v19, a53
    v_mfma_f32_16x16x32_bf16 a[136:139], a[240:243], a[168:171], a[136:139]
    v_accvgpr_read_b32 v20, a54
    v_accvgpr_read_b32 v21, a55
    v_mfma_f32_16x16x32_bf16 a[136:139], a[244:247], a[172:175], a[136:139]
    s_waitcnt lgkmcnt(4)
    v_max3_f32 v8, v8, v18, v19
    v_max3_f32 v8, v8, v20, v21
    v_mfma_f32_16x16x32_bf16 a[124:127], a[248:251], a[152:155], a[124:127]
    ds_read_b128 a[240:243], v5 offset:61440
    v_accvgpr_read_b32 v18, a60
    v_mfma_f32_16x16x32_bf16 a[124:127], a[252:255], a[156:159], a[124:127]
    ds_read_b128 a[244:247], v6 offset:61440
    v_accvgpr_read_b32 v19, a61
    v_mfma_f32_16x16x32_bf16 a[132:135], a[248:251], a[160:163], a[132:135]
    s_add_u32 s42, s27, s98
    v_accvgpr_read_b32 v20, a62
    v_accvgpr_read_b32 v21, a63
    v_mfma_f32_16x16x32_bf16 a[132:135], a[252:255], a[164:167], a[132:135]
    s_add_u32 s42, s42, 0x20000
    v_max3_f32 v9, v9, v18, v19
    v_max3_f32 v9, v9, v20, v21
    v_mfma_f32_16x16x32_bf16 a[140:143], a[248:251], a[168:171], a[140:143]
    s_add_u32 m0, s23, 0x1e000
    v_accvgpr_read_b32 v18, a68
    v_accvgpr_read_b32 v19, a69
    v_mfma_f32_16x16x32_bf16 a[140:143], a[252:255], a[172:175], a[140:143]
    s_waitcnt lgkmcnt(4)
    buffer_load_dwordx4 v1, s[8:11], s42 offen nt lds
    v_accvgpr_read_b32 v20, a70
    v_mfma_f32_16x16x32_bf16 a[144:147], a[224:227], a[152:155], a[144:147]
    ds_read_b128 a[248:251], v5 offset:63488
    v_accvgpr_read_b32 v21, a71
    v_mfma_f32_16x16x32_bf16 a[144:147], a[228:231], a[156:159], a[144:147]
    ds_read_b128 a[252:255], v6 offset:63488
    v_max3_f32 v10, v10, v18, v19
    v_mfma_f32_16x16x32_bf16 v[24:27], a[224:227], a[160:163], v[24:27]
    v_max3_f32 v10, v10, v20, v21
    v_accvgpr_read_b32 v18, a72
    v_mfma_f32_16x16x32_bf16 v[24:27], a[228:231], a[164:167], v[24:27]
    buffer_load_dwordx4 v2, s[8:11], s42 offen offset:1024 nt lds
    v_accvgpr_read_b32 v19, a73
    v_mfma_f32_16x16x32_bf16 v[32:35], a[224:227], a[168:171], v[32:35]
    v_accvgpr_read_b32 v20, a74
    v_accvgpr_read_b32 v21, a75
    v_mfma_f32_16x16x32_bf16 v[32:35], a[228:231], a[172:175], v[32:35]
    s_waitcnt lgkmcnt(4)
    v_max3_f32 v8, v8, v18, v19
    v_max3_f32 v8, v8, v20, v21
    v_mfma_f32_16x16x32_bf16 a[148:151], a[232:235], a[152:155], a[148:151]
    s_waitcnt vmcnt(8)
    s_barrier
    v_add_u32 v5, 0x10000, v5
    v_mfma_f32_16x16x32_bf16 a[148:151], a[236:239], a[156:159], a[148:151]
    s_add_u32 s42, s24, s43
    v_add_u32 v6, 0x10000, v6
    v_accvgpr_read_b32 v18, a80
    v_mfma_f32_16x16x32_bf16 v[28:31], a[232:235], a[160:163], v[28:31]
    s_add_u32 s42, s42, 0x20000
    ds_read_b128 a[224:227], v5 offset:0
    v_accvgpr_read_b32 v19, a81
    v_mfma_f32_16x16x32_bf16 v[28:31], a[236:239], a[164:167], v[28:31]
    s_add_u32 m0, s23, 0
    ds_read_b128 a[228:231], v6 offset:0
    v_accvgpr_read_b32 v20, a82
    v_mfma_f32_16x16x32_bf16 v[36:39], a[232:235], a[168:171], v[36:39]
    buffer_load_dwordx4 v1, s[12:15], s42 offen nt lds
    v_accvgpr_read_b32 v21, a83
    v_mfma_f32_16x16x32_bf16 v[36:39], a[236:239], a[172:175], v[36:39]
    s_waitcnt lgkmcnt(4)
    v_max3_f32 v9, v9, v18, v19
    v_max3_f32 v9, v9, v20, v21
    v_mfma_f32_16x16x32_bf16 v[40:43], a[240:243], a[152:155], v[40:43]
    ds_read_b128 a[232:235], v5 offset:2048
    v_accvgpr_read_b32 v18, a88
    v_mfma_f32_16x16x32_bf16 v[40:43], a[244:247], a[156:159], v[40:43]
    ds_read_b128 a[236:239], v6 offset:2048
    v_accvgpr_read_b32 v19, a89
    v_mfma_f32_16x16x32_bf16 v[48:51], a[240:243], a[160:163], v[48:51]
    buffer_load_dwordx4 v2, s[12:15], s42 offen offset:1024 nt lds
    v_accvgpr_read_b32 v20, a90
    v_mfma_f32_16x16x32_bf16 v[48:51], a[244:247], a[164:167], v[48:51]
    s_add_u32 s42, s24, s96
    v_accvgpr_read_b32 v21, a91
    v_max3_f32 v10, v10, v18, v19
    v_mfma_f32_16x16x32_bf16 v[56:59], a[240:243], a[168:171], v[56:59]
    s_add_u32 s42, s42, 0x20000
    v_max3_f32 v10, v10, v20, v21
    v_accvgpr_read_b32 v18, a76
    v_mfma_f32_16x16x32_bf16 v[56:59], a[244:247], a[172:175], v[56:59]
    s_waitcnt lgkmcnt(4)
    v_accvgpr_read_b32 v19, a77
    v_accvgpr_read_b32 v20, a78
    v_mfma_f32_16x16x32_bf16 v[44:47], a[248:251], a[152:155], v[44:47]
    s_add_u32 m0, s23, 0x2000
    ds_read_b128 a[240:243], v5 offset:4096
    v_accvgpr_read_b32 v21, a79
    v_mfma_f32_16x16x32_bf16 v[44:47], a[252:255], a[156:159], v[44:47]
    ds_read_b128 a[244:247], v6 offset:4096
    v_max3_f32 v8, v8, v18, v19
    v_mfma_f32_16x16x32_bf16 v[52:55], a[248:251], a[160:163], v[52:55]
    buffer_load_dwordx4 v1, s[12:15], s42 offen nt lds
    v_max3_f32 v8, v8, v20, v21
    v_mfma_f32_16x16x32_bf16 v[52:55], a[252:255], a[164:167], v[52:55]
    v_accvgpr_read_b32 v18, a84
    v_accvgpr_read_b32 v19, a85
    v_mfma_f32_16x16x32_bf16 v[60:63], a[248:251], a[168:171], v[60:63]
    v_accvgpr_read_b32 v20, a86
    v_accvgpr_read_b32 v21, a87
    v_mfma_f32_16x16x32_bf16 v[60:63], a[252:255], a[172:175], v[60:63]
    s_waitcnt lgkmcnt(4)
    v_max3_f32 v9, v9, v18, v19
    v_max3_f32 v9, v9, v20, v21
    v_mfma_f32_16x16x32_bf16 v[64:67], a[224:227], a[200:203], v[64:67]
    ds_read_b128 a[248:251], v5 offset:6144
    v_accvgpr_read_b32 v18, a92
    v_mfma_f32_16x16x32_bf16 v[64:67], a[228:231], a[204:207], v[64:67]
    ds_read_b128 a[252:255], v6 offset:6144
    v_accvgpr_read_b32 v19, a93
    v_mfma_f32_16x16x32_bf16 v[72:75], a[224:227], a[208:211], v[72:75]
    buffer_load_dwordx4 v2, s[12:15], s42 offen offset:1024 nt lds
    v_accvgpr_read_b32 v20, a94
    v_mfma_f32_16x16x32_bf16 v[72:75], a[228:231], a[212:215], v[72:75]
    s_add_u32 s42, s24, s97
    v_accvgpr_read_b32 v21, a95
    v_max3_f32 v10, v10, v18, v19
    v_mfma_f32_16x16x32_bf16 v[80:83], a[224:227], a[216:219], v[80:83]
    s_add_u32 s42, s42, 0x20000
    v_max3_f32 v10, v10, v20, v21
    v_accvgpr_read_b32 v18, a96
    v_mfma_f32_16x16x32_bf16 v[80:83], a[228:231], a[220:223], v[80:83]
    s_waitcnt lgkmcnt(4)
    v_accvgpr_read_b32 v19, a97
    v_accvgpr_read_b32 v20, a98
    v_mfma_f32_16x16x32_bf16 v[68:71], a[232:235], a[200:203], v[68:71]
    s_add_u32 m0, s23, 0x4000
    ds_read_b128 a[224:227], v5 offset:8192
    v_accvgpr_read_b32 v21, a99
    v_mfma_f32_16x16x32_bf16 v[68:71], a[236:239], a[204:207], v[68:71]
    ds_read_b128 a[228:231], v6 offset:8192
    v_max3_f32 v8, v8, v18, v19
    v_mfma_f32_16x16x32_bf16 v[76:79], a[232:235], a[208:211], v[76:79]
    buffer_load_dwordx4 v1, s[12:15], s42 offen nt lds
    v_max3_f32 v8, v8, v20, v21
    v_mfma_f32_16x16x32_bf16 v[76:79], a[236:239], a[212:215], v[76:79]
    v_accvgpr_read_b32 v18, a104
    v_accvgpr_read_b32 v19, a105
    v_mfma_f32_16x16x32_bf16 v[84:87], a[232:235], a[216:219], v[84:87]
    v_accvgpr_read_b32 v20, a106
    v_accvgpr_read_b32 v21, a107
    v_mfma_f32_16x16x32_bf16 v[84:87], a[236:239], a[220:223], v[84:87]
    s_waitcnt lgkmcnt(4)
    v_max3_f32 v9, v9, v18, v19
    v_max3_f32 v9, v9, v20, v21
    v_mfma_f32_16x16x32_bf16 v[88:91], a[240:243], a[200:203], v[88:91]
    ds_read_b128 a[232:235], v5 offset:10240
    v_accvgpr_read_b32 v18, a112
    v_mfma_f32_16x16x32_bf16 v[88:91], a[244:247], a[204:207], v[88:91]
    ds_read_b128 a[236:239], v6 offset:10240
    v_accvgpr_read_b32 v19, a113
    v_mfma_f32_16x16x32_bf16 v[96:99], a[240:243], a[208:211], v[96:99]
    buffer_load_dwordx4 v2, s[12:15], s42 offen offset:1024 nt lds
    v_accvgpr_read_b32 v20, a114
    v_mfma_f32_16x16x32_bf16 v[96:99], a[244:247], a[212:215], v[96:99]
    s_add_u32 s42, s24, s98
    v_accvgpr_read_b32 v21, a115
    v_max3_f32 v10, v10, v18, v19
    v_mfma_f32_16x16x32_bf16 v[104:107], a[240:243], a[216:219], v[104:107]
    s_add_u32 s42, s42, 0x20000
    v_max3_f32 v10, v10, v20, v21
    v_accvgpr_read_b32 v18, a100
    v_mfma_f32_16x16x32_bf16 v[104:107], a[244:247], a[220:223], v[104:107]
    s_waitcnt lgkmcnt(4)
    v_accvgpr_read_b32 v19, a101
    v_accvgpr_read_b32 v20, a102
    v_mfma_f32_16x16x32_bf16 v[92:95], a[248:251], a[200:203], v[92:95]
    s_add_u32 m0, s23, 0x6000
    ds_read_b128 a[240:243], v5 offset:12288
    v_accvgpr_read_b32 v21, a103
    v_mfma_f32_16x16x32_bf16 v[92:95], a[252:255], a[204:207], v[92:95]
    ds_read_b128 a[244:247], v6 offset:12288
    v_max3_f32 v8, v8, v18, v19
    v_mfma_f32_16x16x32_bf16 v[100:103], a[248:251], a[208:211], v[100:103]
    buffer_load_dwordx4 v1, s[12:15], s42 offen nt lds
    v_max3_f32 v8, v8, v20, v21
    v_mfma_f32_16x16x32_bf16 v[100:103], a[252:255], a[212:215], v[100:103]
    v_accvgpr_read_b32 v18, a108
    v_accvgpr_read_b32 v19, a109
    v_mfma_f32_16x16x32_bf16 v[108:111], a[248:251], a[216:219], v[108:111]
    v_accvgpr_read_b32 v20, a110
    v_accvgpr_read_b32 v21, a111
    v_mfma_f32_16x16x32_bf16 v[108:111], a[252:255], a[220:223], v[108:111]
    s_waitcnt lgkmcnt(4)
    v_max3_f32 v9, v9, v18, v19
    v_max3_f32 v9, v9, v20, v21
    v_mfma_f32_16x16x32_bf16 v[112:115], a[224:227], a[200:203], v[112:115]
    ds_read_b128 a[248:251], v5 offset:14336
    v_accvgpr_read_b32 v18, a116
    v_mfma_f32_16x16x32_bf16 v[112:115], a[228:231], a[204:207], v[112:115]
    ds_read_b128 a[252:255], v6 offset:14336
    v_accvgpr_read_b32 v19, a117
    v_mfma_f32_16x16x32_bf16 v[120:123], a[224:227], a[208:211], v[120:123]
    buffer_load_dwordx4 v2, s[12:15], s42 offen offset:1024 nt lds
    v_accvgpr_read_b32 v20, a118
    v_mfma_f32_16x16x32_bf16 v[120:123], a[228:231], a[212:215], v[120:123]
    s_add_u32 s42, s25, s43
    v_accvgpr_read_b32 v21, a119
    v_max3_f32 v10, v10, v18, v19
    v_mfma_f32_16x16x32_bf16 v[128:131], a[224:227], a[216:219], v[128:131]
    s_add_u32 s42, s42, 0x20000
    v_max3_f32 v10, v10, v20, v21
    v_accvgpr_read_b32 v18, a120
    v_mfma_f32_16x16x32_bf16 v[128:131], a[228:231], a[220:223], v[128:131]
    s_waitcnt lgkmcnt(4)
    v_accvgpr_read_b32 v19, a121
    v_accvgpr_read_b32 v20, a122
    v_mfma_f32_16x16x32_bf16 v[116:119], a[232:235], a[200:203], v[116:119]
    s_add_u32 m0, s23, 0x20000
    ds_read_b128 a[224:227], v5 offset:16384
    v_accvgpr_read_b32 v21, a123
    v_mfma_f32_16x16x32_bf16 v[116:119], a[236:239], a[204:207], v[116:119]
    ds_read_b128 a[228:231], v6 offset:16384
    v_max3_f32 v8, v8, v18, v19
    v_mfma_f32_16x16x32_bf16 v[124:127], a[232:235], a[208:211], v[124:127]
    buffer_load_dwordx4 v1, s[12:15], s42 offen nt lds
    v_max3_f32 v8, v8, v20, v21
    v_mfma_f32_16x16x32_bf16 v[124:127], a[236:239], a[212:215], v[124:127]
    v_accvgpr_read_b32 v18, a128
    v_accvgpr_read_b32 v19, a129
    v_mfma_f32_16x16x32_bf16 v[132:135], a[232:235], a[216:219], v[132:135]
    v_accvgpr_read_b32 v20, a130
    v_accvgpr_read_b32 v21, a131
    v_mfma_f32_16x16x32_bf16 v[132:135], a[236:239], a[220:223], v[132:135]
    s_waitcnt lgkmcnt(4)
    v_max3_f32 v9, v9, v18, v19
    v_max3_f32 v9, v9, v20, v21
    v_mfma_f32_16x16x32_bf16 v[136:139], a[240:243], a[200:203], v[136:139]
    ds_read_b128 a[232:235], v5 offset:18432
    v_accvgpr_read_b32 v18, a136
    v_mfma_f32_16x16x32_bf16 v[136:139], a[244:247], a[204:207], v[136:139]
    ds_read_b128 a[236:239], v6 offset:18432
    v_accvgpr_read_b32 v19, a137
    v_mfma_f32_16x16x32_bf16 v[144:147], a[240:243], a[208:211], v[144:147]
    buffer_load_dwordx4 v2, s[12:15], s42 offen offset:1024 nt lds
    v_accvgpr_read_b32 v20, a138
    v_mfma_f32_16x16x32_bf16 v[144:147], a[244:247], a[212:215], v[144:147]
    s_add_u32 s42, s25, s96
    v_accvgpr_read_b32 v21, a139
    v_max3_f32 v10, v10, v18, v19
    v_mfma_f32_16x16x32_bf16 v[152:155], a[240:243], a[216:219], v[152:155]
    s_add_u32 s42, s42, 0x20000
    v_max3_f32 v10, v10, v20, v21
    v_accvgpr_read_b32 v18, a124
    v_mfma_f32_16x16x32_bf16 v[152:155], a[244:247], a[220:223], v[152:155]
    s_waitcnt lgkmcnt(4)
    v_accvgpr_read_b32 v19, a125
    v_accvgpr_read_b32 v20, a126
    v_mfma_f32_16x16x32_bf16 v[140:143], a[248:251], a[200:203], v[140:143]
    s_add_u32 m0, s23, 0x22000
    ds_read_b128 a[240:243], v5 offset:20480
    v_accvgpr_read_b32 v21, a127
    v_mfma_f32_16x16x32_bf16 v[140:143], a[252:255], a[204:207], v[140:143]
    ds_read_b128 a[244:247], v6 offset:20480
    v_max3_f32 v8, v8, v18, v19
    v_mfma_f32_16x16x32_bf16 v[148:151], a[248:251], a[208:211], v[148:151]
    buffer_load_dwordx4 v1, s[12:15], s42 offen nt lds
    v_max3_f32 v8, v8, v20, v21
    v_mfma_f32_16x16x32_bf16 v[148:151], a[252:255], a[212:215], v[148:151]
    v_accvgpr_read_b32 v18, a132
    v_accvgpr_read_b32 v19, a133
    v_mfma_f32_16x16x32_bf16 v[156:159], a[248:251], a[216:219], v[156:159]
    v_accvgpr_read_b32 v20, a134
    v_accvgpr_read_b32 v21, a135
    v_mfma_f32_16x16x32_bf16 v[156:159], a[252:255], a[220:223], v[156:159]
    s_waitcnt lgkmcnt(4)
    v_max3_f32 v9, v9, v18, v19
    v_max3_f32 v9, v9, v20, v21
    v_mfma_f32_16x16x32_bf16 v[160:163], a[224:227], a[200:203], v[160:163]
    ds_read_b128 a[248:251], v5 offset:22528
    v_accvgpr_read_b32 v18, a140
    v_mfma_f32_16x16x32_bf16 v[160:163], a[228:231], a[204:207], v[160:163]
    ds_read_b128 a[252:255], v6 offset:22528
    v_accvgpr_read_b32 v19, a141
    v_mfma_f32_16x16x32_bf16 v[168:171], a[224:227], a[208:211], v[168:171]
    buffer_load_dwordx4 v2, s[12:15], s42 offen offset:1024 nt lds
    v_accvgpr_read_b32 v20, a142
    v_mfma_f32_16x16x32_bf16 v[168:171], a[228:231], a[212:215], v[168:171]
    s_add_u32 s42, s25, s97
    v_accvgpr_read_b32 v21, a143
    v_max3_f32 v10, v10, v18, v19
    v_mfma_f32_16x16x32_bf16 v[176:179], a[224:227], a[216:219], v[176:179]
    s_add_u32 s42, s42, 0x20000
    v_max3_f32 v10, v10, v20, v21
    v_accvgpr_read_b32 v18, a144
    v_mfma_f32_16x16x32_bf16 v[176:179], a[228:231], a[220:223], v[176:179]
    s_waitcnt lgkmcnt(4)
    v_accvgpr_read_b32 v19, a145
    v_accvgpr_read_b32 v20, a146
    v_mfma_f32_16x16x32_bf16 v[164:167], a[232:235], a[200:203], v[164:167]
    s_add_u32 m0, s23, 0x24000
    ds_read_b128 a[224:227], v5 offset:24576
    v_accvgpr_read_b32 v21, a147
    v_mfma_f32_16x16x32_bf16 v[164:167], a[236:239], a[204:207], v[164:167]
    ds_read_b128 a[228:231], v6 offset:24576
    v_max3_f32 v8, v8, v18, v19
    v_mfma_f32_16x16x32_bf16 v[172:175], a[232:235], a[208:211], v[172:175]
    buffer_load_dwordx4 v1, s[12:15], s42 offen nt lds
    v_max3_f32 v8, v8, v20, v21
    v_mfma_f32_16x16x32_bf16 v[172:175], a[236:239], a[212:215], v[172:175]
    v_max3_f32 v9, v9, v24, v25
    v_max3_f32 v9, v9, v26, v27
    v_mfma_f32_16x16x32_bf16 v[180:183], a[232:235], a[216:219], v[180:183]
    v_max3_f32 v10, v10, v32, v33
    v_max3_f32 v10, v10, v34, v35
    v_mfma_f32_16x16x32_bf16 v[180:183], a[236:239], a[220:223], v[180:183]
    s_waitcnt lgkmcnt(4)
    v_accvgpr_read_b32 v18, a148
    v_accvgpr_read_b32 v19, a149
    v_mfma_f32_16x16x32_bf16 v[184:187], a[240:243], a[200:203], v[184:187]
    ds_read_b128 a[232:235], v5 offset:26624
    v_accvgpr_read_b32 v20, a150
    v_mfma_f32_16x16x32_bf16 v[184:187], a[244:247], a[204:207], v[184:187]
    ds_read_b128 a[236:239], v6 offset:26624
    v_accvgpr_read_b32 v21, a151
    v_mfma_f32_16x16x32_bf16 v[192:195], a[240:243], a[208:211], v[192:195]
    buffer_load_dwordx4 v2, s[12:15], s42 offen offset:1024 nt lds
    v_max3_f32 v8, v8, v18, v19
    v_mfma_f32_16x16x32_bf16 v[192:195], a[244:247], a[212:215], v[192:195]
    s_add_u32 s42, s25, s98
    v_max3_f32 v8, v8, v20, v21
    v_max3_f32 v9, v9, v28, v29
    v_mfma_f32_16x16x32_bf16 v[200:203], a[240:243], a[216:219], v[200:203]
    s_add_u32 s42, s42, 0x20000
    v_max3_f32 v9, v9, v30, v31
    v_max3_f32 v10, v10, v36, v37
    v_mfma_f32_16x16x32_bf16 v[200:203], a[244:247], a[220:223], v[200:203]
    s_waitcnt lgkmcnt(4)
    v_max3_f32 v10, v10, v38, v39
    v_max3_f32 v8, v8, v40, v41
    v_mfma_f32_16x16x32_bf16 v[188:191], a[248:251], a[200:203], v[188:191]
    s_add_u32 m0, s23, 0x26000
    ds_read_b128 a[240:243], v5 offset:28672
    v_max3_f32 v8, v8, v42, v43
    v_mfma_f32_16x16x32_bf16 v[188:191], a[252:255], a[204:207], v[188:191]
    ds_read_b128 a[244:247], v6 offset:28672
    v_max3_f32 v9, v9, v48, v49
    v_mfma_f32_16x16x32_bf16 v[196:199], a[248:251], a[208:211], v[196:199]
    buffer_load_dwordx4 v1, s[12:15], s42 offen nt lds
    v_max3_f32 v9, v9, v50, v51
    v_mfma_f32_16x16x32_bf16 v[196:199], a[252:255], a[212:215], v[196:199]
    v_max3_f32 v10, v10, v56, v57
    v_max3_f32 v10, v10, v58, v59
    v_mfma_f32_16x16x32_bf16 v[204:207], a[248:251], a[216:219], v[204:207]
    v_max3_f32 v8, v8, v44, v45
    v_max3_f32 v8, v8, v46, v47
    v_mfma_f32_16x16x32_bf16 v[204:207], a[252:255], a[220:223], v[204:207]
    s_waitcnt lgkmcnt(4)
    v_max3_f32 v9, v9, v52, v53
    v_max3_f32 v9, v9, v54, v55
    v_mfma_f32_16x16x32_bf16 v[208:211], a[224:227], a[200:203], v[208:211]
    ds_read_b128 a[248:251], v5 offset:30720
    v_max3_f32 v10, v10, v60, v61
    v_mfma_f32_16x16x32_bf16 v[208:211], a[228:231], a[204:207], v[208:211]
    ds_read_b128 a[252:255], v6 offset:30720
    v_max3_f32 v10, v10, v62, v63
    v_mfma_f32_16x16x32_bf16 v[216:219], a[224:227], a[208:211], v[216:219]
    buffer_load_dwordx4 v2, s[12:15], s42 offen offset:1024 nt lds
    v_mfma_f32_16x16x32_bf16 v[216:219], a[228:231], a[212:215], v[216:219]
    v_mfma_f32_16x16x32_bf16 v[224:227], a[224:227], a[216:219], v[224:227]
    v_mfma_f32_16x16x32_bf16 v[224:227], a[228:231], a[220:223], v[224:227]
    s_waitcnt lgkmcnt(4)
    v_mfma_f32_16x16x32_bf16 v[212:215], a[232:235], a[200:203], v[212:215]
    s_waitcnt vmcnt(16)
    s_barrier
    ds_read_b128 a[224:227], v5 offset:32768
    v_mfma_f32_16x16x32_bf16 v[212:215], a[236:239], a[204:207], v[212:215]
    s_add_u32 s42, s24, s43
    ds_read_b128 a[228:231], v6 offset:32768
    v_mfma_f32_16x16x32_bf16 v[220:223], a[232:235], a[208:211], v[220:223]
    s_add_u32 m0, s23, 0x8000
    v_mfma_f32_16x16x32_bf16 v[220:223], a[236:239], a[212:215], v[220:223]
    buffer_load_dwordx4 v1, s[12:15], s42 offen nt lds
    v_mfma_f32_16x16x32_bf16 v[228:231], a[232:235], a[216:219], v[228:231]
    v_mfma_f32_16x16x32_bf16 v[228:231], a[236:239], a[220:223], v[228:231]
    s_waitcnt lgkmcnt(4)
    v_mfma_f32_16x16x32_bf16 v[232:235], a[240:243], a[200:203], v[232:235]
L_pg3:
    s_cbranch_execz L_warm_done1
    ds_read_b128 a[232:235], v5 offset:34816
    v_mfma_f32_16x16x32_bf16 v[232:235], a[244:247], a[204:207], v[232:235]
    ds_read_b128 a[236:239], v6 offset:34816
    v_mfma_f32_16x16x32_bf16 v[240:243], a[240:243], a[208:211], v[240:243]
    buffer_load_dwordx4 v2, s[12:15], s42 offen offset:1024 nt lds
    v_mfma_f32_16x16x32_bf16 v[240:243], a[244:247], a[212:215], v[240:243]
    s_add_u32 s42, s24, s96
    v_mfma_f32_16x16x32_bf16 v[248:251], a[240:243], a[216:219], v[248:251]
    s_add_u32 m0, s23, 0xa000
    v_mfma_f32_16x16x32_bf16 v[248:251], a[244:247], a[220:223], v[248:251]
    s_waitcnt lgkmcnt(4)
    v_mfma_f32_16x16x32_bf16 v[236:239], a[248:251], a[200:203], v[236:239]
    ds_read_b128 a[240:243], v5 offset:36864
    v_mfma_f32_16x16x32_bf16 v[236:239], a[252:255], a[204:207], v[236:239]
    ds_read_b128 a[244:247], v6 offset:36864
    v_mfma_f32_16x16x32_bf16 v[244:247], a[248:251], a[208:211], v[244:247]
    buffer_load_dwordx4 v1, s[12:15], s42 offen nt lds
    v_mfma_f32_16x16x32_bf16 v[244:247], a[252:255], a[212:215], v[244:247]
    v_mfma_f32_16x16x32_bf16 v[252:255], a[248:251], a[216:219], v[252:255]
    v_mfma_f32_16x16x32_bf16 v[252:255], a[252:255], a[220:223], v[252:255]
    s_waitcnt lgkmcnt(4)
    v_mfma_f32_16x16x32_bf16 v[64:67], a[224:227], a[152:155], v[64:67]
    ds_read_b128 a[248:251], v5 offset:38912
    v_mfma_f32_16x16x32_bf16 v[64:67], a[228:231], a[156:159], v[64:67]
    ds_read_b128 a[252:255], v6 offset:38912
    v_mfma_f32_16x16x32_bf16 v[72:75], a[224:227], a[160:163], v[72:75]
    buffer_load_dwordx4 v2, s[12:15], s42 offen offset:1024 nt lds
    v_mfma_f32_16x16x32_bf16 v[72:75], a[228:231], a[164:167], v[72:75]
    s_add_u32 s42, s24, s97
    v_mfma_f32_16x16x32_bf16 v[80:83], a[224:227], a[168:171], v[80:83]
    s_add_u32 m0, s23, 0xc000
    v_mfma_f32_16x16x32_bf16 v[80:83], a[228:231], a[172:175], v[80:83]
    s_waitcnt lgkmcnt(4)
    v_mfma_f32_16x16x32_bf16 v[68:71], a[232:235], a[152:155], v[68:71]
    ds_read_b128 a[224:227], v5 offset:40960
    v_max3_f32 v8, v8, v64, v65
    v_mfma_f32_16x16x32_bf16 v[68:71], a[236:239], a[156:159], v[68:71]
    ds_read_b128 a[228:231], v6 offset:40960
    v_max3_f32 v8, v8, v66, v67
    v_mfma_f32_16x16x32_bf16 v[76:79], a[232:235], a[160:163], v[76:79]
    buffer_load_dwordx4 v1, s[12:15], s42 offen nt lds
    v_max3_f32 v9, v9, v72, v73
    v_mfma_f32_16x16x32_bf16 v[76:79], a[236:239], a[164:167], v[76:79]
    v_max3_f32 v9, v9, v74, v75
    v_mfma_f32_16x16x32_bf16 v[84:87], a[232:235], a[168:171], v[84:87]
    v_max3_f32 v10, v10, v80, v81
    v_max3_f32 v10, v10, v82, v83
    v_mfma_f32_16x16x32_bf16 v[84:87], a[236:239], a[172:175], v[84:87]
    s_waitcnt lgkmcnt(4)
    v_mfma_f32_16x16x32_bf16 v[88:91], a[240:243], a[152:155], v[88:91]
    ds_read_b128 a[232:235], v5 offset:43008
    v_max3_f32 v8, v8, v68, v69
    v_mfma_f32_16x16x32_bf16 v[88:91], a[244:247], a[156:159], v[88:91]
    ds_read_b128 a[236:239], v6 offset:43008
    v_max3_f32 v8, v8, v70, v71
    v_mfma_f32_16x16x32_bf16 v[96:99], a[240:243], a[160:163], v[96:99]
    buffer_load_dwordx4 v2, s[12:15], s42 offen offset:1024 nt lds
    v_max3_f32 v9, v9, v76, v77
    v_mfma_f32_16x16x32_bf16 v[96:99], a[244:247], a[164:167], v[96:99]
    s_add_u32 s42, s24, s98
    v_max3_f32 v9, v9, v78, v79
    v_mfma_f32_16x16x32_bf16 v[104:107], a[240:243], a[168:171], v[104:107]
    s_add_u32 m0, s23, 0xe000
    v_max3_f32 v10, v10, v84, v85
    v_max3_f32 v10, v10, v86, v87
    v_mfma_f32_16x16x32_bf16 v[104:107], a[244:247], a[172:175], v[104:107]
    s_waitcnt lgkmcnt(4)
    v_mfma_f32_16x16x32_bf16 v[92:95], a[248:251], a[152:155], v[92:95]
    ds_read_b128 a[240:243], v5 offset:45056
    v_max3_f32 v8, v8, v88, v89
    v_mfma_f32_16x16x32_bf16 v[92:95], a[252:255], a[156:159], v[92:95]
    ds_read_b128 a[244:247], v6 offset:45056
    v_max3_f32 v8, v8, v90, v91
    v_mfma_f32_16x16x32_bf16 v[100:103], a[248:251], a[160:163], v[100:103]
    buffer_load_dwordx4 v1, s[12:15], s42 offen nt lds
    v_max3_f32 v9, v9, v96, v97
    v_mfma_f32_16x16x32_bf16 v[100:103], a[252:255], a[164:167], v[100:103]
    v_max3_f32 v9, v9, v98, v99
    v_mfma_f32_16x16x32_bf16 v[108:111], a[248:251], a[168:171], v[108:111]
    v_max3_f32 v10, v10, v104, v105
    v_max3_f32 v10, v10, v106, v107
    v_mfma_f32_16x16x32_bf16 v[108:111], a[252:255], a[172:175], v[108:111]
    s_waitcnt lgkmcnt(4)
    v_mfma_f32_16x16x32_bf16 v[112:115], a[224:227], a[152:155], v[112:115]
    ds_read_b128 a[248:251], v5 offset:47104
    v_max3_f32 v8, v8, v92, v93
    v_mfma_f32_16x16x32_bf16 v[112:115], a[228:231], a[156:159], v[112:115]
    ds_read_b128 a[252:255], v6 offset:47104
    v_max3_f32 v8, v8, v94, v95
    v_mfma_f32_16x16x32_bf16 v[120:123], a[224:227], a[160:163], v[120:123]
    buffer_load_dwordx4 v2, s[12:15], s42 offen offset:1024 nt lds
    v_max3_f32 v9, v9, v100, v101
    v_mfma_f32_16x16x32_bf16 v[120:123], a[228:231], a[164:167], v[120:123]
    v_max3_f32 v9, v9, v102, v103
    v_mfma_f32_16x16x32_bf16 v[128:131], a[224:227], a[168:171], v[128:131]
    v_max3_f32 v10, v10, v108, v109
    v_max3_f32 v10, v10, v110, v111
    v_mfma_f32_16x16x32_bf16 v[128:131], a[228:231], a[172:175], v[128:131]
    s_waitcnt lgkmcnt(4)
    v_mfma_f32_16x16x32_bf16 v[116:119], a[232:235], a[152:155], v[116:119]
    ds_read_b128 a[224:227], v5 offset:49152
    v_max3_f32 v8, v8, v112, v113
    v_mfma_f32_16x16x32_bf16 v[116:119], a[236:239], a[156:159], v[116:119]
    ds_read_b128 a[228:231], v6 offset:49152
    v_max3_f32 v8, v8, v114, v115
    v_mfma_f32_16x16x32_bf16 v[124:127], a[232:235], a[160:163], v[124:127]
    v_max3_f32 v9, v9, v120, v121
    v_max3_f32 v9, v9, v122, v123
    v_mfma_f32_16x16x32_bf16 v[124:127], a[236:239], a[164:167], v[124:127]
    v_mfma_f32_16x16x32_bf16 v[132:135], a[232:235], a[168:171], v[132:135]
    v_max3_f32 v10, v10, v128, v129
    v_max3_f32 v10, v10, v130, v131
    v_mfma_f32_16x16x32_bf16 v[132:135], a[236:239], a[172:175], v[132:135]
    s_waitcnt lgkmcnt(4)
    v_mfma_f32_16x16x32_bf16 v[136:139], a[240:243], a[152:155], v[136:139]
    ds_read_b128 a[232:235], v5 offset:51200
    v_max3_f32 v8, v8, v116, v117
    v_mfma_f32_16x16x32_bf16 v[136:139], a[244:247], a[156:159], v[136:139]
    ds_read_b128 a[236:239], v6 offset:51200
    v_max3_f32 v8, v8, v118, v119
    v_mfma_f32_16x16x32_bf16 v[144:147], a[240:243], a[160:163], v[144:147]
    v_max3_f32 v9, v9, v124, v125
    v_max3_f32 v9, v9, v126, v127
    v_mfma_f32_16x16x32_bf16 v[144:147], a[244:247], a[164:167], v[144:147]
    v_mfma_f32_16x16x32_bf16 v[152:155], a[240:243], a[168:171], v[152:155]
    v_max3_f32 v10, v10, v132, v133
    v_max3_f32 v10, v10, v134, v135
    v_mfma_f32_16x16x32_bf16 v[152:155], a[244:247], a[172:175], v[152:155]
    s_waitcnt lgkmcnt(4)
    v_mfma_f32_16x16x32_bf16 v[140:143], a[248:251], a[152:155], v[140:143]
    ds_read_b128 a[240:243], v5 offset:53248
    v_max3_f32 v8, v8, v136, v137
    v_mfma_f32_16x16x32_bf16 v[140:143], a[252:255], a[156:159], v[140:143]
    ds_read_b128 a[244:247], v6 offset:53248
    v_max3_f32 v8, v8, v138, v139
    v_mfma_f32_16x16x32_bf16 v[148:151], a[248:251], a[160:163], v[148:151]
    v_max3_f32 v9, v9, v144, v145
    v_max3_f32 v9, v9, v146, v147
    v_mfma_f32_16x16x32_bf16 v[148:151], a[252:255], a[164:167], v[148:151]
    v_mfma_f32_16x16x32_bf16 v[156:159], a[248:251], a[168:171], v[156:159]
    v_max3_f32 v10, v10, v152, v153
    v_max3_f32 v10, v10, v154, v155
    v_mfma_f32_16x16x32_bf16 v[156:159], a[252:255], a[172:175], v[156:159]
    s_waitcnt lgkmcnt(4)
    buffer_load_dword v23, v22, s[12:15], s47 offen sc0
    v_and_b32 v22, 0x1fff, v22
    v_mfma_f32_16x16x32_bf16 v[160:163], a[224:227], a[152:155], v[160:163]
    ds_read_b128 a[248:251], v5 offset:55296
    v_max3_f32 v8, v8, v140, v141
    v_mfma_f32_16x16x32_bf16 v[160:163], a[228:231], a[156:159], v[160:163]
    ds_read_b128 a[252:255], v6 offset:55296
    v_max3_f32 v8, v8, v142, v143
    v_mfma_f32_16x16x32_bf16 v[168:171], a[224:227], a[160:163], v[168:171]
    v_max3_f32 v9, v9, v148, v149
    v_max3_f32 v9, v9, v150, v151
    v_mfma_f32_16x16x32_bf16 v[168:171], a[228:231], a[164:167], v[168:171]
    v_mfma_f32_16x16x32_bf16 v[176:179], a[224:227], a[168:171], v[176:179]
    v_max3_f32 v10, v10, v156, v157
    v_max3_f32 v10, v10, v158, v159
    v_mfma_f32_16x16x32_bf16 v[176:179], a[228:231], a[172:175], v[176:179]
    s_waitcnt lgkmcnt(4)
    v_mfma_f32_16x16x32_bf16 v[164:167], a[232:235], a[152:155], v[164:167]
    ds_read_b128 a[224:227], v5 offset:57344
    v_max3_f32 v8, v8, v160, v161
    v_mfma_f32_16x16x32_bf16 v[164:167], a[236:239], a[156:159], v[164:167]
    ds_read_b128 a[228:231], v6 offset:57344
    v_max3_f32 v8, v8, v162, v163
    v_mfma_f32_16x16x32_bf16 v[172:175], a[232:235], a[160:163], v[172:175]
    buffer_load_dword v23, v22, s[12:15], s48 offen sc0
    v_max3_f32 v9, v9, v168, v169
    v_mfma_f32_16x16x32_bf16 v[172:175], a[236:239], a[164:167], v[172:175]
    v_max3_f32 v9, v9, v170, v171
    v_mfma_f32_16x16x32_bf16 v[180:183], a[232:235], a[168:171], v[180:183]
    v_max3_f32 v10, v10, v176, v177
    v_max3_f32 v10, v10, v178, v179
    v_mfma_f32_16x16x32_bf16 v[180:183], a[236:239], a[172:175], v[180:183]
    s_waitcnt lgkmcnt(4)
    v_mfma_f32_16x16x32_bf16 v[184:187], a[240:243], a[152:155], v[184:187]
    ds_read_b128 a[232:235], v5 offset:59392
    v_max3_f32 v8, v8, v164, v165
    v_mfma_f32_16x16x32_bf16 v[184:187], a[244:247], a[156:159], v[184:187]
    ds_read_b128 a[236:239], v6 offset:59392
    v_max3_f32 v8, v8, v166, v167
    v_mfma_f32_16x16x32_bf16 v[192:195], a[240:243], a[160:163], v[192:195]
    v_max3_f32 v9, v9, v172, v173
    v_max3_f32 v9, v9, v174, v175
    v_mfma_f32_16x16x32_bf16 v[192:195], a[244:247], a[164:167], v[192:195]
    v_mfma_f32_16x16x32_bf16 v[200:203], a[240:243], a[168:171], v[200:203]
    v_max3_f32 v10, v10, v180, v181
    v_max3_f32 v10, v10, v182, v183
    v_mfma_f32_16x16x32_bf16 v[200:203], a[244:247], a[172:175], v[200:203]
    s_waitcnt lgkmcnt(4)
    v_mfma_f32_16x16x32_bf16 v[188:191], a[248:251], a[152:155], v[188:191]
    ds_read_b128 a[240:243], v5 offset:61440
    v_max3_f32 v8, v8, v184, v185
    v_mfma_f32_16x16x32_bf16 v[188:191], a[252:255], a[156:159], v[188:191]
    ds_read_b128 a[244:247], v6 offset:61440
    v_max3_f32 v8, v8, v186, v187
    v_mfma_f32_16x16x32_bf16 v[196:199], a[248:251], a[160:163], v[196:199]
    v_max3_f32 v9, v9, v192, v193
    v_max3_f32 v9, v9, v194, v195
    v_mfma_f32_16x16x32_bf16 v[196:199], a[252:255], a[164:167], v[196:199]
    v_mfma_f32_16x16x32_bf16 v[204:207], a[248:251], a[168:171], v[204:207]
    v_max3_f32 v10, v10, v200, v201
    v_max3_f32 v10, v10, v202, v203
    v_mfma_f32_16x16x32_bf16 v[204:207], a[252:255], a[172:175], v[204:207]
    s_waitcnt lgkmcnt(4)
    v_mfma_f32_16x16x32_bf16 v[208:211], a[224:227], a[152:155], v[208:211]
    ds_read_b128 a[248:251], v5 offset:63488
    v_max3_f32 v8, v8, v188, v189
    v_mfma_f32_16x16x32_bf16 v[208:211], a[228:231], a[156:159], v[208:211]
    ds_read_b128 a[252:255], v6 offset:63488
    v_max3_f32 v8, v8, v190, v191
    v_mfma_f32_16x16x32_bf16 v[216:219], a[224:227], a[160:163], v[216:219]
    v_max3_f32 v9, v9, v196, v197
    v_max3_f32 v9, v9, v198, v199
    v_mfma_f32_16x16x32_bf16 v[216:219], a[228:231], a[164:167], v[216:219]
    v_mfma_f32_16x16x32_bf16 v[224:227], a[224:227], a[168:171], v[224:227]
    v_max3_f32 v10, v10, v204, v205
    v_max3_f32 v10, v10, v206, v207
    v_mfma_f32_16x16x32_bf16 v[224:227], a[228:231], a[172:175], v[224:227]
    s_waitcnt lgkmcnt(4)
    v_mfma_f32_16x16x32_bf16 v[212:215], a[232:235], a[152:155], v[212:215]
    v_max3_f32 v8, v8, v208, v209
    v_max3_f32 v8, v8, v210, v211
    v_mfma_f32_16x16x32_bf16 v[212:215], a[236:239], a[156:159], v[212:215]
    v_mfma_f32_16x16x32_bf16 v[220:223], a[232:235], a[160:163], v[220:223]
    v_max3_f32 v9, v9, v216, v217
    v_max3_f32 v9, v9, v218, v219
    v_mfma_f32_16x16x32_bf16 v[220:223], a[236:239], a[164:167], v[220:223]
    v_mfma_f32_16x16x32_bf16 v[228:231], a[232:235], a[168:171], v[228:231]
    v_max3_f32 v10, v10, v224, v225
    v_max3_f32 v10, v10, v226, v227
    v_mfma_f32_16x16x32_bf16 v[228:231], a[236:239], a[172:175], v[228:231]
    s_waitcnt lgkmcnt(2)
    v_mfma_f32_16x16x32_bf16 v[232:235], a[240:243], a[152:155], v[232:235]
    v_max3_f32 v8, v8, v212, v213
    v_max3_f32 v8, v8, v214, v215
    v_mfma_f32_16x16x32_bf16 v[232:235], a[244:247], a[156:159], v[232:235]
    v_mfma_f32_16x16x32_bf16 v[240:243], a[240:243], a[160:163], v[240:243]
    v_max3_f32 v9, v9, v220, v221
    v_max3_f32 v9, v9, v222, v223
    v_mfma_f32_16x16x32_bf16 v[240:243], a[244:247], a[164:167], v[240:243]
    v_mfma_f32_16x16x32_bf16 v[248:251], a[240:243], a[168:171], v[248:251]
    v_max3_f32 v10, v10, v228, v229
    v_max3_f32 v10, v10, v230, v231
    v_mfma_f32_16x16x32_bf16 v[248:251], a[244:247], a[172:175], v[248:251]
    s_waitcnt lgkmcnt(0)
    v_mfma_f32_16x16x32_bf16 v[236:239], a[248:251], a[152:155], v[236:239]
    v_max3_f32 v8, v8, v232, v233
    v_max3_f32 v8, v8, v234, v235
    v_mfma_f32_16x16x32_bf16 v[236:239], a[252:255], a[156:159], v[236:239]
    v_mfma_f32_16x16x32_bf16 v[244:247], a[248:251], a[160:163], v[244:247]
    v_max3_f32 v9, v9, v240, v241
    v_max3_f32 v9, v9, v242, v243
    v_mfma_f32_16x16x32_bf16 v[244:247], a[252:255], a[164:167], v[244:247]
    v_mfma_f32_16x16x32_bf16 v[252:255], a[248:251], a[168:171], v[252:255]
    v_max3_f32 v10, v10, v248, v249
    v_max3_f32 v10, v10, v250, v251
    v_mfma_f32_16x16x32_bf16 v[252:255], a[252:255], a[172:175], v[252:255]
    s_barrier
    s_nop 5
    v_max3_f32 v8, v8, v236, v237
    v_max3_f32 v8, v8, v238, v239
    v_max3_f32 v9, v9, v244, v245
    v_max3_f32 v9, v9, v246, v247
    v_max3_f32 v10, v10, v252, v253
    v_max3_f32 v10, v10, v254, v255
    v_mov_b32 v18, v8
    v_mov_b32 v19, v9
    v_mov_b32 v20, v10
    s_nop 0
    v_permlane32_swap_b32 v8, v18
    v_permlane32_swap_b32 v9, v19
    v_permlane32_swap_b32 v10, v20
    v_max_f32 v8, v8, v18
    v_max_f32 v9, v9, v19
    v_max_f32 v10, v10, v20
    v_mov_b32 v18, v8
    v_mov_b32 v19, v9
    v_mov_b32 v20, v10
    s_nop 0
    v_permlane16_swap_b32 v8, v18
    v_permlane16_swap_b32 v9, v19
    v_permlane16_swap_b32 v10, v20
    v_max_f32 v8, v8, v18
    v_max_f32 v9, v9, v19
    v_max_f32 v10, v10, v20
    v_mul_f32 v8, v8, s40
    v_sub_f32 v12, 0, v8
    v_sub_f32 v13, 0, v8
    v_mul_f32 v9, v9, s40
    v_sub_f32 v14, 0, v9
    v_sub_f32 v15, 0, v9
    v_mul_f32 v10, v10, s40
    v_sub_f32 v16, 0, v10
    v_sub_f32 v17, 0, v10
    v_mov_b32 v21, 0x3f803f80
    v_accvgpr_write_b32 a224, v21
    v_accvgpr_write_b32 a225, v21
    v_accvgpr_write_b32 a226, v21
    v_accvgpr_write_b32 a227, v21
    v_pk_fma_f32 v[64:65], v[64:65], s[40:41], v[12:13]
    v_pk_fma_f32 v[66:67], v[66:67], s[40:41], v[12:13]
    v_pk_fma_f32 v[68:69], v[68:69], s[40:41], v[12:13]
    v_pk_fma_f32 v[70:71], v[70:71], s[40:41], v[12:13]
    v_exp_f32 v64, v64
    v_exp_f32 v65, v65
    v_pk_fma_f32 v[72:73], v[72:73], s[40:41], v[14:15]
    v_exp_f32 v66, v66
    v_exp_f32 v67, v67
    v_pk_fma_f32 v[74:75], v[74:75], s[40:41], v[14:15]
    v_exp_f32 v68, v68
    v_exp_f32 v69, v69
    v_pk_fma_f32 v[76:77], v[76:77], s[40:41], v[14:15]
    v_exp_f32 v70, v70
    v_exp_f32 v71, v71
    v_pk_fma_f32 v[78:79], v[78:79], s[40:41], v[14:15]
    v_exp_f32 v72, v72
    v_exp_f32 v73, v73
    v_cvt_pk_bf16_f32 v64, v64, v65
    v_pk_fma_f32 v[80:81], v[80:81], s[40:41], v[16:17]
    v_exp_f32 v74, v74
    v_exp_f32 v75, v75
    v_cvt_pk_bf16_f32 v65, v66, v67
    v_pk_fma_f32 v[82:83], v[82:83], s[40:41], v[16:17]
    v_exp_f32 v76, v76
    v_exp_f32 v77, v77
    v_cvt_pk_bf16_f32 v66, v68, v69
    v_pk_fma_f32 v[84:85], v[84:85], s[40:41], v[16:17]
    v_exp_f32 v78, v78
    v_exp_f32 v79, v79
    v_cvt_pk_bf16_f32 v67, v70, v71
    v_pk_fma_f32 v[86:87], v[86:87], s[40:41], v[16:17]
    v_exp_f32 v80, v80
    v_exp_f32 v81, v81
    v_cvt_pk_bf16_f32 v72, v72, v73
    v_pk_fma_f32 v[88:89], v[88:89], s[40:41], v[12:13]
    v_mfma_f32_16x16x32_bf16 a[232:235], a[224:227], v[64:67], 0
    v_exp_f32 v82, v82
    v_exp_f32 v83, v83
    v_cvt_pk_bf16_f32 v73, v74, v75
    v_pk_fma_f32 v[90:91], v[90:91], s[40:41], v[12:13]
    v_exp_f32 v84, v84
    v_exp_f32 v85, v85
    v_cvt_pk_bf16_f32 v74, v76, v77
    v_pk_fma_f32 v[92:93], v[92:93], s[40:41], v[12:13]
    v_exp_f32 v86, v86
    v_exp_f32 v87, v87
    v_cvt_pk_bf16_f32 v75, v78, v79
    v_pk_fma_f32 v[94:95], v[94:95], s[40:41], v[12:13]
    v_exp_f32 v88, v88
    v_exp_f32 v89, v89
    v_cvt_pk_bf16_f32 v80, v80, v81
    v_pk_fma_f32 v[96:97], v[96:97], s[40:41], v[14:15]
    v_mfma_f32_16x16x32_bf16 a[236:239], a[224:227], v[72:75], 0
    v_exp_f32 v90, v90
    v_exp_f32 v91, v91
    v_cvt_pk_bf16_f32 v81, v82, v83
    v_pk_fma_f32 v[98:99], v[98:99], s[40:41], v[14:15]
    v_exp_f32 v92, v92
    v_exp_f32 v93, v93
    v_cvt_pk_bf16_f32 v82, v84, v85
    v_pk_fma_f32 v[100:101], v[100:101], s[40:41], v[14:15]
    v_exp_f32 v94, v94
    v_exp_f32 v95, v95
    v_cvt_pk_bf16_f32 v83, v86, v87
    v_pk_fma_f32 v[102:103], v[102:103], s[40:41], v[14:15]
    v_exp_f32 v96, v96
    v_exp_f32 v97, v97
    v_cvt_pk_bf16_f32 v88, v88, v89
    v_pk_fma_f32 v[104:105], v[104:105], s[40:41], v[16:17]
    v_mfma_f32_16x16x32_bf16 a[240:243], a[224:227], v[80:83], 0
    v_exp_f32 v98, v98
    v_exp_f32 v99, v99
    v_cvt_pk_bf16_f32 v89, v90, v91
    v_pk_fma_f32 v[106:107], v[106:107], s[40:41], v[16:17]
    v_exp_f32 v100, v100
    v_exp_f32 v101, v101
    v_cvt_pk_bf16_f32 v90, v92, v93
    v_pk_fma_f32 v[108:109], v[108:109], s[40:41], v[16:17]
    v_exp_f32 v102, v102
    v_exp_f32 v103, v103
    v_cvt_pk_bf16_f32 v91, v94, v95
    v_pk_fma_f32 v[110:111], v[110:111], s[40:41], v[16:17]
    v_exp_f32 v104, v104
    v_exp_f32 v105, v105
    v_cvt_pk_bf16_f32 v96, v96, v97
    v_pk_fma_f32 v[112:113], v[112:113], s[40:41], v[12:13]
    v_mfma_f32_16x16x32_bf16 a[232:235], a[224:227], v[88:91], a[232:235]
    v_exp_f32 v106, v106
    v_exp_f32 v107, v107
    v_cvt_pk_bf16_f32 v97, v98, v99
    v_pk_fma_f32 v[114:115], v[114:115], s[40:41], v[12:13]
    v_exp_f32 v108, v108
    v_exp_f32 v109, v109
    v_cvt_pk_bf16_f32 v98, v100, v101
    v_pk_fma_f32 v[116:117], v[116:117], s[40:41], v[12:13]
    v_exp_f32 v110, v110
    v_exp_f32 v111, v111
    v_cvt_pk_bf16_f32 v99, v102, v103
    v_pk_fma_f32 v[118:119], v[118:119], s[40:41], v[12:13]
    v_exp_f32 v112, v112
    v_exp_f32 v113, v113
    v_cvt_pk_bf16_f32 v104, v104, v105
    v_pk_fma_f32 v[120:121], v[120:121], s[40:41], v[14:15]
    v_mfma_f32_16x16x32_bf16 a[236:239], a[224:227], v[96:99], a[236:239]
    v_exp_f32 v114, v114
    v_exp_f32 v115, v115
    v_cvt_pk_bf16_f32 v105, v106, v107
    v_pk_fma_f32 v[122:123], v[122:123], s[40:41], v[14:15]
    v_exp_f32 v116, v116
    v_exp_f32 v117, v117
    v_cvt_pk_bf16_f32 v106, v108, v109
    v_pk_fma_f32 v[124:125], v[124:125], s[40:41], v[14:15]
    v_exp_f32 v118, v118
    v_exp_f32 v119, v119
    v_cvt_pk_bf16_f32 v107, v110, v111
    v_pk_fma_f32 v[126:127], v[126:127], s[40:41], v[14:15]
    v_exp_f32 v120, v120
    v_exp_f32 v121, v121
    v_cvt_pk_bf16_f32 v112, v112, v113
    v_pk_fma_f32 v[128:129], v[128:129], s[40:41], v[16:17]
    v_mfma_f32_16x16x32_bf16 a[240:243], a[224:227], v[104:107], a[240:243]
    v_exp_f32 v122, v122
    v_exp_f32 v123, v123
    v_cvt_pk_bf16_f32 v113, v114, v115
    v_pk_fma_f32 v[130:131], v[130:131], s[40:41], v[16:17]
    v_exp_f32 v124, v124
    v_exp_f32 v125, v125
    v_cvt_pk_bf16_f32 v114, v116, v117
    v_pk_fma_f32 v[132:133], v[132:133], s[40:41], v[16:17]
    v_exp_f32 v126, v126
    v_exp_f32 v127, v127
    v_cvt_pk_bf16_f32 v115, v118, v119
    v_pk_fma_f32 v[134:135], v[134:135], s[40:41], v[16:17]
    v_exp_f32 v128, v128
    v_exp_f32 v129, v129
    v_cvt_pk_bf16_f32 v120, v120, v121
    v_pk_fma_f32 v[136:137], v[136:137], s[40:41], v[12:13]
    v_mfma_f32_16x16x32_bf16 a[232:235], a[224:227], v[112:115], a[232:235]
    v_exp_f32 v130, v130
    v_exp_f32 v131, v131
    v_cvt_pk_bf16_f32 v121, v122, v123
    v_pk_fma_f32 v[138:139], v[138:139], s[40:41], v[12:13]
    v_exp_f32 v132, v132
    v_exp_f32 v133, v133
    v_cvt_pk_bf16_f32 v122, v124, v125
    v_pk_fma_f32 v[140:141], v[140:141], s[40:41], v[12:13]
    v_exp_f32 v134, v134
    v_exp_f32 v135, v135
    v_cvt_pk_bf16_f32 v123, v126, v127
    v_pk_fma_f32 v[142:143], v[142:143], s[40:41], v[12:13]
    v_exp_f32 v136, v136
    v_exp_f32 v137, v137
    v_cvt_pk_bf16_f32 v128, v128, v129
    v_pk_fma_f32 v[144:145], v[144:145], s[40:41], v[14:15]
    v_mfma_f32_16x16x32_bf16 a[236:239], a[224:227], v[120:123], a[236:239]
    v_exp_f32 v138, v138
    v_exp_f32 v139, v139
    v_cvt_pk_bf16_f32 v129, v130, v131
    v_pk_fma_f32 v[146:147], v[146:147], s[40:41], v[14:15]
    v_exp_f32 v140, v140
    v_exp_f32 v141, v141
    v_cvt_pk_bf16_f32 v130, v132, v133
    v_pk_fma_f32 v[148:149], v[148:149], s[40:41], v[14:15]
    v_exp_f32 v142, v142
    v_exp_f32 v143, v143
    v_cvt_pk_bf16_f32 v131, v134, v135
    v_pk_fma_f32 v[150:151], v[150:151], s[40:41], v[14:15]
    v_exp_f32 v144, v144
    v_exp_f32 v145, v145
    v_cvt_pk_bf16_f32 v136, v136, v137
    v_pk_fma_f32 v[152:153], v[152:153], s[40:41], v[16:17]
    v_mfma_f32_16x16x32_bf16 a[240:243], a[224:227], v[128:131], a[240:243]
    v_exp_f32 v146, v146
    v_exp_f32 v147, v147
    v_cvt_pk_bf16_f32 v137, v138, v139
    v_pk_fma_f32 v[154:155], v[154:155], s[40:41], v[16:17]
    v_exp_f32 v148, v148
    v_exp_f32 v149, v149
    v_cvt_pk_bf16_f32 v138, v140, v141
    v_pk_fma_f32 v[156:157], v[156:157], s[40:41], v[16:17]
    v_exp_f32 v150, v150
    v_exp_f32 v151, v151
    v_cvt_pk_bf16_f32 v139, v142, v143
    v_pk_fma_f32 v[158:159], v[158:159], s[40:41], v[16:17]
    v_exp_f32 v152, v152
    v_exp_f32 v153, v153
    v_cvt_pk_bf16_f32 v144, v144, v145
    v_pk_fma_f32 v[160:161], v[160:161], s[40:41], v[12:13]
    v_mfma_f32_16x16x32_bf16 a[232:235], a[224:227], v[136:139], a[232:235]
    v_exp_f32 v154, v154
    v_exp_f32 v155, v155
    v_cvt_pk_bf16_f32 v145, v146, v147
    v_pk_fma_f32 v[162:163], v[162:163], s[40:41], v[12:13]
    v_exp_f32 v156, v156
    v_exp_f32 v157, v157
    v_cvt_pk_bf16_f32 v146, v148, v149
    v_pk_fma_f32 v[164:165], v[164:165], s[40:41], v[12:13]
    v_exp_f32 v158, v158
    v_exp_f32 v159, v159
    v_cvt_pk_bf16_f32 v147, v150, v151
    v_pk_fma_f32 v[166:167], v[166:167], s[40:41], v[12:13]
    v_exp_f32 v160, v160
    v_exp_f32 v161, v161
    v_cvt_pk_bf16_f32 v152, v152, v153
    v_pk_fma_f32 v[168:169], v[168:169], s[40:41], v[14:15]
    v_mfma_f32_16x16x32_bf16 a[236:239], a[224:227], v[144:147], a[236:239]
    v_exp_f32 v162, v162
    v_exp_f32 v163, v163
    v_cvt_pk_bf16_f32 v153, v154, v155
    v_pk_fma_f32 v[170:171], v[170:171], s[40:41], v[14:15]
    v_exp_f32 v164, v164
    v_exp_f32 v165, v165
    v_cvt_pk_bf16_f32 v154, v156, v157
    v_pk_fma_f32 v[172:173], v[172:173], s[40:41], v[14:15]
    v_exp_f32 v166, v166
    v_exp_f32 v167, v167
    v_cvt_pk_bf16_f32 v155, v158, v159
    v_pk_fma_f32 v[174:175], v[174:175], s[40:41], v[14:15]
    v_exp_f32 v168, v168
    v_exp_f32 v169, v169
    v_cvt_pk_bf16_f32 v160, v160, v161
    v_pk_fma_f32 v[176:177], v[176:177], s[40:41], v[16:17]
    v_mfma_f32_16x16x32_bf16 a[240:243], a[224:227], v[152:155], a[240:243]
    v_exp_f32 v170, v170
    v_exp_f32 v171, v171
    v_cvt_pk_bf16_f32 v161, v162, v163
    v_pk_fma_f32 v[178:179], v[178:179], s[40:41], v[16:17]
    v_exp_f32 v172, v172
    v_exp_f32 v173, v173
    v_cvt_pk_bf16_f32 v162, v164, v165
    v_pk_fma_f32 v[180:181], v[180:181], s[40:41], v[16:17]
    v_exp_f32 v174, v174
    v_exp_f32 v175, v175
    v_cvt_pk_bf16_f32 v163, v166, v167
    v_pk_fma_f32 v[182:183], v[182:183], s[40:41], v[16:17]
    v_exp_f32 v176, v176
    v_exp_f32 v177, v177
    v_cvt_pk_bf16_f32 v168, v168, v169
    v_pk_fma_f32 v[184:185], v[184:185], s[40:41], v[12:13]
    v_mfma_f32_16x16x32_bf16 a[232:235], a[224:227], v[160:163], a[232:235]
    v_exp_f32 v178, v178
    v_exp_f32 v179, v179
    v_cvt_pk_bf16_f32 v169, v170, v171
    v_pk_fma_f32 v[186:187], v[186:187], s[40:41], v[12:13]
    v_exp_f32 v180, v180
    v_exp_f32 v181, v181
    v_cvt_pk_bf16_f32 v170, v172, v173
    v_pk_fma_f32 v[188:189], v[188:189], s[40:41], v[12:13]
    v_exp_f32 v182, v182
    v_exp_f32 v183, v183
    v_cvt_pk_bf16_f32 v171, v174, v175
    v_pk_fma_f32 v[190:191], v[190:191], s[40:41], v[12:13]
    v_exp_f32 v184, v184
    v_exp_f32 v185, v185
    v_cvt_pk_bf16_f32 v176, v176, v177
    v_pk_fma_f32 v[192:193], v[192:193], s[40:41], v[14:15]
    v_mfma_f32_16x16x32_bf16 a[236:239], a[224:227], v[168:171], a[236:239]
    v_exp_f32 v186, v186
    v_exp_f32 v187, v187
    v_cvt_pk_bf16_f32 v177, v178, v179
    v_pk_fma_f32 v[194:195], v[194:195], s[40:41], v[14:15]
    v_exp_f32 v188, v188
    v_exp_f32 v189, v189
    v_cvt_pk_bf16_f32 v178, v180, v181
    v_pk_fma_f32 v[196:197], v[196:197], s[40:41], v[14:15]
    v_exp_f32 v190, v190
    v_exp_f32 v191, v191
    v_cvt_pk_bf16_f32 v179, v182, v183
    v_pk_fma_f32 v[198:199], v[198:199], s[40:41], v[14:15]
    v_exp_f32 v192, v192
    v_exp_f32 v193, v193
    v_cvt_pk_bf16_f32 v184, v184, v185
    v_pk_fma_f32 v[200:201], v[200:201], s[40:41], v[16:17]
    v_mfma_f32_16x16x32_bf16 a[240:243], a[224:227], v[176:179], a[240:243]
    v_exp_f32 v194, v194
    v_exp_f32 v195, v195
    v_cvt_pk_bf16_f32 v185, v186, v187
    v_pk_fma_f32 v[202:203], v[202:203], s[40:41], v[16:17]
    v_exp_f32 v196, v196
    v_exp_f32 v197, v197
    v_cvt_pk_bf16_f32 v186, v188, v189
    v_pk_fma_f32 v[204:205], v[204:205], s[40:41], v[16:17]
    v_exp_f32 v198, v198
    v_exp_f32 v199, v199
    v_cvt_pk_bf16_f32 v187, v190, v191
    v_pk_fma_f32 v[206:207], v[206:207], s[40:41], v[16:17]
    v_exp_f32 v200, v200
    v_exp_f32 v201, v201
    v_cvt_pk_bf16_f32 v192, v192, v193
    v_pk_fma_f32 v[208:209], v[208:209], s[40:41], v[12:13]
    v_mfma_f32_16x16x32_bf16 a[232:235], a[224:227], v[184:187], a[232:235]
    v_exp_f32 v202, v202
    v_exp_f32 v203, v203
    v_cvt_pk_bf16_f32 v193, v194, v195
    v_pk_fma_f32 v[210:211], v[210:211], s[40:41], v[12:13]
    v_exp_f32 v204, v204
    v_exp_f32 v205, v205
    v_cvt_pk_bf16_f32 v194, v196, v197
    v_pk_fma_f32 v[212:213], v[212:213], s[40:41], v[12:13]
    v_exp_f32 v206, v206
    v_exp_f32 v207, v207
    v_cvt_pk_bf16_f32 v195, v198, v199
    v_pk_fma_f32 v[214:215], v[214:215], s[40:41], v[12:13]
    v_exp_f32 v208, v208
    v_exp_f32 v209, v209
L_pg4:
    s_cbranch_execz L_warm_done1
    v_cvt_pk_bf16_f32 v200, v200, v201
    v_pk_fma_f32 v[216:217], v[216:217], s[40:41], v[14:15]
    v_mfma_f32_16x16x32_bf16 a[236:239], a[224:227], v[192:195], a[236:239]
    v_exp_f32 v210, v210
    v_exp_f32 v211, v211
    v_cvt_pk_bf16_f32 v201, v202, v203
    v_pk_fma_f32 v[218:219], v[218:219], s[40:41], v[14:15]
    v_exp_f32 v212, v212
    v_exp_f32 v213, v213
    v_cvt_pk_bf16_f32 v202, v204, v205
    v_pk_fma_f32 v[220:221], v[220:221], s[40:41], v[14:15]
    v_exp_f32 v214, v214
    v_exp_f32 v215, v215
    v_cvt_pk_bf16_f32 v203, v206, v207
    v_pk_fma_f32 v[222:223], v[222:223], s[40:41], v[14:15]
    v_exp_f32 v216, v216
    v_exp_f32 v217, v217
    v_cvt_pk_bf16_f32 v208, v208, v209
    v_pk_fma_f32 v[224:225], v[224:225], s[40:41], v[16:17]
    v_mfma_f32_16x16x32_bf16 a[240:243], a[224:227], v[200:203], a[240:243]
    v_exp_f32 v218, v218
    v_exp_f32 v219, v219
    v_cvt_pk_bf16_f32 v209, v210, v211
    v_pk_fma_f32 v[226:227], v[226:227], s[40:41], v[16:17]
    v_exp_f32 v220, v220
    v_exp_f32 v221, v221
    v_cvt_pk_bf16_f32 v210, v212, v213
    v_pk_fma_f32 v[228:229], v[228:229], s[40:41], v[16:17]
    v_exp_f32 v222, v222
    v_exp_f32 v223, v223
    v_cvt_pk_bf16_f32 v211, v214, v215
    v_pk_fma_f32 v[230:231], v[230:231], s[40:41], v[16:17]
    v_exp_f32 v224, v224
    v_exp_f32 v225, v225
    v_cvt_pk_bf16_f32 v216, v216, v217
    v_pk_fma_f32 v[232:233], v[232:233], s[40:41], v[12:13]
    v_mfma_f32_16x16x32_bf16 a[232:235], a[224:227], v[208:211], a[232:235]
    v_exp_f32 v226, v226
    v_exp_f32 v227, v227
    v_cvt_pk_bf16_f32 v217, v218, v219
    v_pk_fma_f32 v[234:235], v[234:235], s[40:41], v[12:13]
    v_exp_f32 v228, v228
    v_exp_f32 v229, v229
    v_cvt_pk_bf16_f32 v218, v220, v221
    v_pk_fma_f32 v[236:237], v[236:237], s[40:41], v[12:13]
    v_exp_f32 v230, v230
    v_exp_f32 v231, v231
    v_cvt_pk_bf16_f32 v219, v222, v223
    v_pk_fma_f32 v[238:239], v[238:239], s[40:41], v[12:13]
    v_exp_f32 v232, v232
    v_exp_f32 v233, v233
    v_cvt_pk_bf16_f32 v224, v224, v225
    v_pk_fma_f32 v[240:241], v[240:241], s[40:41], v[14:15]
    v_mfma_f32_16x16x32_bf16 a[236:239], a[224:227], v[216:219], a[236:239]
    v_exp_f32 v234, v234
    v_exp_f32 v235, v235
    v_cvt_pk_bf16_f32 v225, v226, v227
    v_pk_fma_f32 v[242:243], v[242:243], s[40:41], v[14:15]
    v_exp_f32 v236, v236
    v_exp_f32 v237, v237
    v_cvt_pk_bf16_f32 v226, v228, v229
    v_pk_fma_f32 v[244:245], v[244:245], s[40:41], v[14:15]
    v_exp_f32 v238, v238
    v_exp_f32 v239, v239
    v_cvt_pk_bf16_f32 v227, v230, v231
    v_pk_fma_f32 v[246:247], v[246:247], s[40:41], v[14:15]
    v_exp_f32 v240, v240
    v_exp_f32 v241, v241
    v_cvt_pk_bf16_f32 v232, v232, v233
    v_pk_fma_f32 v[248:249], v[248:249], s[40:41], v[16:17]
    v_mfma_f32_16x16x32_bf16 a[240:243], a[224:227], v[224:227], a[240:243]
    v_exp_f32 v242, v242
    v_exp_f32 v243, v243
    v_cvt_pk_bf16_f32 v233, v234, v235
    v_pk_fma_f32 v[250:251], v[250:251], s[40:41], v[16:17]
    v_exp_f32 v244, v244
    v_exp_f32 v245, v245
    v_cvt_pk_bf16_f32 v234, v236, v237
    v_pk_fma_f32 v[252:253], v[252:253], s[40:41], v[16:17]
    v_exp_f32 v246, v246
    v_exp_f32 v247, v247
    v_cvt_pk_bf16_f32 v235, v238, v239
    v_pk_fma_f32 v[254:255], v[254:255], s[40:41], v[16:17]
    v_exp_f32 v248, v248
    v_exp_f32 v249, v249
    v_cvt_pk_bf16_f32 v240, v240, v241
    v_pk_fma_f32 v[24:25], v[24:25], s[40:41], v[14:15]
    v_mfma_f32_16x16x32_bf16 a[232:235], a[224:227], v[232:235], a[232:235]
    v_exp_f32 v250, v250
    v_exp_f32 v251, v251
    v_cvt_pk_bf16_f32 v241, v242, v243
    v_pk_fma_f32 v[26:27], v[26:27], s[40:41], v[14:15]
    v_exp_f32 v252, v252
    v_exp_f32 v253, v253
    v_cvt_pk_bf16_f32 v242, v244, v245
    v_pk_fma_f32 v[28:29], v[28:29], s[40:41], v[14:15]
    v_exp_f32 v254, v254
    v_exp_f32 v255, v255
    v_cvt_pk_bf16_f32 v243, v246, v247
    v_pk_fma_f32 v[30:31], v[30:31], s[40:41], v[14:15]
    v_exp_f32 v24, v24
    v_exp_f32 v25, v25
    v_cvt_pk_bf16_f32 v248, v248, v249
    v_pk_fma_f32 v[32:33], v[32:33], s[40:41], v[16:17]
    v_mfma_f32_16x16x32_bf16 a[236:239], a[224:227], v[240:243], a[236:239]
    v_exp_f32 v26, v26
    v_exp_f32 v27, v27
    v_cvt_pk_bf16_f32 v249, v250, v251
    v_pk_fma_f32 v[34:35], v[34:35], s[40:41], v[16:17]
    v_exp_f32 v28, v28
    v_exp_f32 v29, v29
    v_cvt_pk_bf16_f32 v250, v252, v253
    v_pk_fma_f32 v[36:37], v[36:37], s[40:41], v[16:17]
    v_exp_f32 v30, v30
    v_exp_f32 v31, v31
    v_cvt_pk_bf16_f32 v251, v254, v255
    v_pk_fma_f32 v[38:39], v[38:39], s[40:41], v[16:17]
    v_exp_f32 v32, v32
    v_exp_f32 v33, v33
    v_cvt_pk_bf16_f32 v24, v24, v25
    v_pk_fma_f32 v[40:41], v[40:41], s[40:41], v[12:13]
    v_mfma_f32_16x16x32_bf16 a[240:243], a[224:227], v[248:251], a[240:243]
    v_exp_f32 v34, v34
    v_exp_f32 v35, v35
    v_cvt_pk_bf16_f32 v25, v26, v27
    v_pk_fma_f32 v[42:43], v[42:43], s[40:41], v[12:13]
    v_exp_f32 v36, v36
    v_exp_f32 v37, v37
    v_cvt_pk_bf16_f32 v26, v28, v29
    v_pk_fma_f32 v[44:45], v[44:45], s[40:41], v[12:13]
    v_exp_f32 v38, v38
    v_exp_f32 v39, v39
    v_cvt_pk_bf16_f32 v27, v30, v31
    v_pk_fma_f32 v[46:47], v[46:47], s[40:41], v[12:13]
    v_exp_f32 v40, v40
    v_exp_f32 v41, v41
    v_cvt_pk_bf16_f32 v32, v32, v33
    v_pk_fma_f32 v[48:49], v[48:49], s[40:41], v[14:15]
    v_mfma_f32_16x16x32_bf16 a[236:239], a[224:227], v[24:27], a[236:239]
    v_exp_f32 v42, v42
    v_exp_f32 v43, v43
    v_cvt_pk_bf16_f32 v33, v34, v35
    v_pk_fma_f32 v[50:51], v[50:51], s[40:41], v[14:15]
    v_exp_f32 v44, v44
    v_exp_f32 v45, v45
    v_cvt_pk_bf16_f32 v34, v36, v37
    v_pk_fma_f32 v[52:53], v[52:53], s[40:41], v[14:15]
    v_exp_f32 v46, v46
    v_exp_f32 v47, v47
    v_cvt_pk_bf16_f32 v35, v38, v39
    v_pk_fma_f32 v[54:55], v[54:55], s[40:41], v[14:15]
    v_exp_f32 v48, v48
    v_exp_f32 v49, v49
    v_cvt_pk_bf16_f32 v40, v40, v41
    v_pk_fma_f32 v[56:57], v[56:57], s[40:41], v[16:17]
    v_accvgpr_read_b32 v68, a0
    v_accvgpr_read_b32 v69, a1
    v_mfma_f32_16x16x32_bf16 a[240:243], a[224:227], v[32:35], a[240:243]
    v_exp_f32 v50, v50
    v_exp_f32 v51, v51
    v_cvt_pk_bf16_f32 v41, v42, v43
    v_pk_fma_f32 v[58:59], v[58:59], s[40:41], v[16:17]
    v_accvgpr_read_b32 v70, a2
    v_accvgpr_read_b32 v71, a3
    v_exp_f32 v52, v52
    v_exp_f32 v53, v53
    v_cvt_pk_bf16_f32 v42, v44, v45
    v_pk_fma_f32 v[60:61], v[60:61], s[40:41], v[16:17]
    v_accvgpr_read_b32 v76, a4
    v_accvgpr_read_b32 v77, a5
    v_exp_f32 v54, v54
    v_exp_f32 v55, v55
    v_cvt_pk_bf16_f32 v43, v46, v47
    v_pk_fma_f32 v[62:63], v[62:63], s[40:41], v[16:17]
    v_accvgpr_read_b32 v78, a6
    v_accvgpr_read_b32 v79, a7
    v_exp_f32 v56, v56
    v_exp_f32 v57, v57
    v_cvt_pk_bf16_f32 v48, v48, v49
    v_pk_fma_f32 v[68:69], v[68:69], s[40:41], v[12:13]
    v_accvgpr_read_b32 v84, a8
    v_accvgpr_read_b32 v85, a9
    v_mfma_f32_16x16x32_bf16 a[232:235], a[224:227], v[40:43], a[232:235]
    v_exp_f32 v58, v58
    v_exp_f32 v59, v59
    v_cvt_pk_bf16_f32 v49, v50, v51
    v_pk_fma_f32 v[70:71], v[70:71], s[40:41], v[12:13]
    v_accvgpr_read_b32 v86, a10
    v_accvgpr_read_b32 v87, a11
    v_exp_f32 v60, v60
    v_exp_f32 v61, v61
    v_cvt_pk_bf16_f32 v50, v52, v53
    v_pk_fma_f32 v[76:77], v[76:77], s[40:41], v[12:13]
    v_accvgpr_read_b32 v92, a12
    v_accvgpr_read_b32 v93, a13
    v_exp_f32 v62, v62
    v_exp_f32 v63, v63
    v_cvt_pk_bf16_f32 v51, v54, v55
    v_pk_fma_f32 v[78:79], v[78:79], s[40:41], v[12:13]
    v_accvgpr_read_b32 v94, a14
    v_accvgpr_read_b32 v95, a15
    v_exp_f32 v68, v68
    v_exp_f32 v69, v69
    v_cvt_pk_bf16_f32 v56, v56, v57
    v_pk_fma_f32 v[84:85], v[84:85], s[40:41], v[14:15]
    v_accvgpr_read_b32 v100, a16
    v_accvgpr_read_b32 v101, a17
    v_mfma_f32_16x16x32_bf16 a[236:239], a[224:227], v[48:51], a[236:239]
    v_exp_f32 v70, v70
    v_exp_f32 v71, v71
    v_cvt_pk_bf16_f32 v57, v58, v59
    v_pk_fma_f32 v[86:87], v[86:87], s[40:41], v[14:15]
    v_accvgpr_read_b32 v102, a18
    v_accvgpr_read_b32 v103, a19
    v_exp_f32 v76, v76
    v_exp_f32 v77, v77
    v_cvt_pk_bf16_f32 v58, v60, v61
    v_pk_fma_f32 v[92:93], v[92:93], s[40:41], v[14:15]
    v_accvgpr_read_b32 v108, a20
    v_accvgpr_read_b32 v109, a21
    v_exp_f32 v78, v78
    v_exp_f32 v79, v79
    v_cvt_pk_bf16_f32 v59, v62, v63
    v_pk_fma_f32 v[94:95], v[94:95], s[40:41], v[14:15]
    v_accvgpr_read_b32 v110, a22
    v_accvgpr_read_b32 v111, a23
    v_exp_f32 v84, v84
    v_exp_f32 v85, v85
    v_cvt_pk_bf16_f32 v68, v68, v69
    v_pk_fma_f32 v[100:101], v[100:101], s[40:41], v[16:17]
    v_accvgpr_read_b32 v116, a24
    v_accvgpr_read_b32 v117, a25
    v_mfma_f32_16x16x32_bf16 a[240:243], a[224:227], v[56:59], a[240:243]
    v_exp_f32 v86, v86
    v_exp_f32 v87, v87
    v_cvt_pk_bf16_f32 v69, v70, v71
    v_pk_fma_f32 v[102:103], v[102:103], s[40:41], v[16:17]
    v_accvgpr_read_b32 v118, a26
    v_accvgpr_read_b32 v119, a27
    v_exp_f32 v92, v92
    v_exp_f32 v93, v93
    v_cvt_pk_bf16_f32 v70, v76, v77
    v_pk_fma_f32 v[108:109], v[108:109], s[40:41], v[16:17]
    v_accvgpr_read_b32 v124, a28
    v_accvgpr_read_b32 v125, a29
    v_exp_f32 v94, v94
    v_exp_f32 v95, v95
    v_cvt_pk_bf16_f32 v71, v78, v79
    v_pk_fma_f32 v[110:111], v[110:111], s[40:41], v[16:17]
    v_accvgpr_read_b32 v126, a30
    v_accvgpr_read_b32 v127, a31
    v_exp_f32 v100, v100
    v_exp_f32 v101, v101
    v_cvt_pk_bf16_f32 v84, v84, v85
    v_pk_fma_f32 v[116:117], v[116:117], s[40:41], v[12:13]
    v_accvgpr_read_b32 v132, a32
    v_accvgpr_read_b32 v133, a33
    v_mfma_f32_16x16x32_bf16 a[232:235], a[224:227], v[68:71], a[232:235]
    v_exp_f32 v102, v102
    v_exp_f32 v103, v103
    v_cvt_pk_bf16_f32 v85, v86, v87
    v_pk_fma_f32 v[118:119], v[118:119], s[40:41], v[12:13]
    v_accvgpr_read_b32 v134, a34
    v_accvgpr_read_b32 v135, a35
    v_exp_f32 v108, v108
    v_exp_f32 v109, v109
    v_cvt_pk_bf16_f32 v86, v92, v93
    v_pk_fma_f32 v[124:125], v[124:125], s[40:41], v[12:13]
    v_accvgpr_read_b32 v140, a36
    v_accvgpr_read_b32 v141, a37
    v_exp_f32 v110, v110
    v_exp_f32 v111, v111
    v_cvt_pk_bf16_f32 v87, v94, v95
    v_pk_fma_f32 v[126:127], v[126:127], s[40:41], v[12:13]
    v_accvgpr_read_b32 v142, a38
    v_accvgpr_read_b32 v143, a39
    v_exp_f32 v116, v116
    v_exp_f32 v117, v117
    v_cvt_pk_bf16_f32 v100, v100, v101
    v_pk_fma_f32 v[132:133], v[132:133], s[40:41], v[14:15]
    v_accvgpr_read_b32 v148, a40
    v_accvgpr_read_b32 v149, a41
    v_mfma_f32_16x16x32_bf16 a[236:239], a[224:227], v[84:87], a[236:239]
    v_exp_f32 v118, v118
    v_exp_f32 v119, v119
    v_cvt_pk_bf16_f32 v101, v102, v103
    v_pk_fma_f32 v[134:135], v[134:135], s[40:41], v[14:15]
    v_accvgpr_read_b32 v150, a42
    v_accvgpr_read_b32 v151, a43
    v_exp_f32 v124, v124
    v_exp_f32 v125, v125
    v_cvt_pk_bf16_f32 v102, v108, v109
    v_pk_fma_f32 v[140:141], v[140:141], s[40:41], v[14:15]
    v_accvgpr_read_b32 v156, a44
    v_accvgpr_read_b32 v157, a45
    v_exp_f32 v126, v126
    v_exp_f32 v127, v127
    v_cvt_pk_bf16_f32 v103, v110, v111
    v_pk_fma_f32 v[142:143], v[142:143], s[40:41], v[14:15]
    v_accvgpr_read_b32 v158, a46
    v_accvgpr_read_b32 v159, a47
    v_exp_f32 v132, v132
    v_exp_f32 v133, v133
    v_cvt_pk_bf16_f32 v116, v116, v117
    v_pk_fma_f32 v[148:149], v[148:149], s[40:41], v[16:17]
    v_accvgpr_read_b32 v164, a48
    v_accvgpr_read_b32 v165, a49
    v_mfma_f32_16x16x32_bf16 a[240:243], a[224:227], v[100:103], a[240:243]
    v_exp_f32 v134, v134
    v_exp_f32 v135, v135
    v_cvt_pk_bf16_f32 v117, v118, v119
    v_pk_fma_f32 v[150:151], v[150:151], s[40:41], v[16:17]
    v_accvgpr_read_b32 v166, a50
    v_accvgpr_read_b32 v167, a51
    v_exp_f32 v140, v140
    v_exp_f32 v141, v141
    v_cvt_pk_bf16_f32 v118, v124, v125
    v_pk_fma_f32 v[156:157], v[156:157], s[40:41], v[16:17]
    v_accvgpr_read_b32 v172, a52
    v_accvgpr_read_b32 v173, a53
    v_exp_f32 v142, v142
    v_exp_f32 v143, v143
    v_cvt_pk_bf16_f32 v119, v126, v127
    v_pk_fma_f32 v[158:159], v[158:159], s[40:41], v[16:17]
    v_accvgpr_read_b32 v174, a54
    v_accvgpr_read_b32 v175, a55
    v_exp_f32 v148, v148
    v_exp_f32 v149, v149
    v_cvt_pk_bf16_f32 v132, v132, v133
    v_pk_fma_f32 v[164:165], v[164:165], s[40:41], v[12:13]
    v_accvgpr_read_b32 v180, a56
    v_accvgpr_read_b32 v181, a57
    v_mfma_f32_16x16x32_bf16 a[232:235], a[224:227], v[116:119], a[232:235]
    v_exp_f32 v150, v150
    v_exp_f32 v151, v151
    v_cvt_pk_bf16_f32 v133, v134, v135
    v_pk_fma_f32 v[166:167], v[166:167], s[40:41], v[12:13]
    v_accvgpr_read_b32 v182, a58
    v_accvgpr_read_b32 v183, a59
    v_exp_f32 v156, v156
    v_exp_f32 v157, v157
    v_cvt_pk_bf16_f32 v134, v140, v141
    v_pk_fma_f32 v[172:173], v[172:173], s[40:41], v[12:13]
    v_accvgpr_read_b32 v188, a60
    v_accvgpr_read_b32 v189, a61
    v_exp_f32 v158, v158
    v_exp_f32 v159, v159
    v_cvt_pk_bf16_f32 v135, v142, v143
    v_pk_fma_f32 v[174:175], v[174:175], s[40:41], v[12:13]
    v_accvgpr_read_b32 v190, a62
    v_accvgpr_read_b32 v191, a63
    v_exp_f32 v164, v164
    v_exp_f32 v165, v165
    v_cvt_pk_bf16_f32 v148, v148, v149
    v_pk_fma_f32 v[180:181], v[180:181], s[40:41], v[14:15]
    v_accvgpr_read_b32 v196, a64
    v_accvgpr_read_b32 v197, a65
    v_mfma_f32_16x16x32_bf16 a[236:239], a[224:227], v[132:135], a[236:239]
    v_exp_f32 v166, v166
    v_exp_f32 v167, v167
    v_cvt_pk_bf16_f32 v149, v150, v151
    v_pk_fma_f32 v[182:183], v[182:183], s[40:41], v[14:15]
    v_accvgpr_read_b32 v198, a66
    v_accvgpr_read_b32 v199, a67
    v_exp_f32 v172, v172
    v_exp_f32 v173, v173
    v_cvt_pk_bf16_f32 v150, v156, v157
    v_pk_fma_f32 v[188:189], v[188:189], s[40:41], v[14:15]
    v_accvgpr_read_b32 v204, a68
    v_accvgpr_read_b32 v205, a69
    v_exp_f32 v174, v174
    v_exp_f32 v175, v175
    v_cvt_pk_bf16_f32 v151, v158, v159
    v_pk_fma_f32 v[190:191], v[190:191], s[40:41], v[14:15]
    v_accvgpr_read_b32 v206, a70
    v_accvgpr_read_b32 v207, a71
    v_exp_f32 v180, v180
    v_exp_f32 v181, v181
    v_cvt_pk_bf16_f32 v164, v164, v165
    v_pk_fma_f32 v[196:197], v[196:197], s[40:41], v[16:17]
    v_accvgpr_read_b32 v212, a72
    v_accvgpr_read_b32 v213, a73
    v_mfma_f32_16x16x32_bf16 a[240:243], a[224:227], v[148:151], a[240:243]
    v_exp_f32 v182, v182
    v_exp_f32 v183, v183
    v_cvt_pk_bf16_f32 v165, v166, v167
    v_pk_fma_f32 v[198:199], v[198:199], s[40:41], v[16:17]
    v_accvgpr_read_b32 v214, a74
    v_accvgpr_read_b32 v215, a75
    v_exp_f32 v188, v188
    v_exp_f32 v189, v189
    v_cvt_pk_bf16_f32 v166, v172, v173
    v_pk_fma_f32 v[204:205], v[204:205], s[40:41], v[16:17]
    v_accvgpr_read_b32 v220, a76
    v_accvgpr_read_b32 v221, a77
    v_exp_f32 v190, v190
    v_exp_f32 v191, v191
    v_cvt_pk_bf16_f32 v167, v174, v175
    v_pk_fma_f32 v[206:207], v[206:207], s[40:41], v[16:17]
    v_accvgpr_read_b32 v222, a78
    v_accvgpr_read_b32 v223, a79
    v_exp_f32 v196, v196
    v_exp_f32 v197, v197
    v_cvt_pk_bf16_f32 v180, v180, v181
    v_pk_fma_f32 v[212:213], v[212:213], s[40:41], v[12:13]
    v_accvgpr_read_b32 v228, a80
    v_accvgpr_read_b32 v229, a81
    v_mfma_f32_16x16x32_bf16 a[232:235], a[224:227], v[164:167], a[232:235]
    v_exp_f32 v198, v198
    v_exp_f32 v199, v199
    v_cvt_pk_bf16_f32 v181, v182, v183
    v_pk_fma_f32 v[214:215], v[214:215], s[40:41], v[12:13]
    v_accvgpr_read_b32 v230, a82
    v_accvgpr_read_b32 v231, a83
    v_exp_f32 v204, v204
    v_exp_f32 v205, v205
    v_cvt_pk_bf16_f32 v182, v188, v189
    v_pk_fma_f32 v[220:221], v[220:221], s[40:41], v[12:13]
    v_accvgpr_read_b32 v236, a84
    v_accvgpr_read_b32 v237, a85
    v_exp_f32 v206, v206
    v_exp_f32 v207, v207
    v_cvt_pk_bf16_f32 v183, v190, v191
    v_pk_fma_f32 v[222:223], v[222:223], s[40:41], v[12:13]
    v_accvgpr_read_b32 v238, a86
    v_accvgpr_read_b32 v239, a87
    v_exp_f32 v212, v212
    v_exp_f32 v213, v213
    v_cvt_pk_bf16_f32 v196, v196, v197
    v_pk_fma_f32 v[228:229], v[228:229], s[40:41], v[14:15]
    v_accvgpr_read_b32 v244, a88
    v_accvgpr_read_b32 v245, a89
    v_mfma_f32_16x16x32_bf16 a[236:239], a[224:227], v[180:183], a[236:239]
    v_exp_f32 v214, v214
    v_exp_f32 v215, v215
    v_cvt_pk_bf16_f32 v197, v198, v199
    v_pk_fma_f32 v[230:231], v[230:231], s[40:41], v[14:15]
    v_accvgpr_read_b32 v246, a90
    v_accvgpr_read_b32 v247, a91
    v_exp_f32 v220, v220
    v_exp_f32 v221, v221
    v_cvt_pk_bf16_f32 v198, v204, v205
    v_pk_fma_f32 v[236:237], v[236:237], s[40:41], v[14:15]
    v_accvgpr_read_b32 v252, a92
    v_accvgpr_read_b32 v253, a93
    v_exp_f32 v222, v222
    v_exp_f32 v223, v223
    v_cvt_pk_bf16_f32 v199, v206, v207
    v_pk_fma_f32 v[238:239], v[238:239], s[40:41], v[14:15]
    v_accvgpr_read_b32 v254, a94
    v_accvgpr_read_b32 v255, a95
    v_exp_f32 v228, v228
    v_exp_f32 v229, v229
    v_cvt_pk_bf16_f32 v212, v212, v213
    v_pk_fma_f32 v[244:245], v[244:245], s[40:41], v[16:17]
    v_accvgpr_read_b32 v28, a96
    v_accvgpr_read_b32 v29, a97
    v_mfma_f32_16x16x32_bf16 a[240:243], a[224:227], v[196:199], a[240:243]
    v_exp_f32 v230, v230
    v_exp_f32 v231, v231
    v_cvt_pk_bf16_f32 v213, v214, v215
    v_pk_fma_f32 v[246:247], v[246:247], s[40:41], v[16:17]
    v_accvgpr_read_b32 v30, a98
    v_accvgpr_read_b32 v31, a99
    v_exp_f32 v236, v236
    v_exp_f32 v237, v237
    v_cvt_pk_bf16_f32 v214, v220, v221
    v_pk_fma_f32 v[252:253], v[252:253], s[40:41], v[16:17]
    v_accvgpr_read_b32 v36, a100
    v_accvgpr_read_b32 v37, a101
    v_exp_f32 v238, v238
    v_exp_f32 v239, v239
    v_cvt_pk_bf16_f32 v215, v222, v223
    v_pk_fma_f32 v[254:255], v[254:255], s[40:41], v[16:17]
    v_accvgpr_read_b32 v38, a102
    v_accvgpr_read_b32 v39, a103
    v_exp_f32 v244, v244
    v_exp_f32 v245, v245
    v_cvt_pk_bf16_f32 v228, v228, v229
    v_pk_fma_f32 v[28:29], v[28:29], s[40:41], v[12:13]
    v_accvgpr_read_b32 v44, a104
    v_accvgpr_read_b32 v45, a105
    v_mfma_f32_16x16x32_bf16 a[232:235], a[224:227], v[212:215], a[232:235]
    v_exp_f32 v246, v246
    v_exp_f32 v247, v247
    v_cvt_pk_bf16_f32 v229, v230, v231
    v_pk_fma_f32 v[30:31], v[30:31], s[40:41], v[12:13]
    v_accvgpr_read_b32 v46, a106
    v_accvgpr_read_b32 v47, a107
    v_exp_f32 v252, v252
    v_exp_f32 v253, v253
    v_cvt_pk_bf16_f32 v230, v236, v237
    v_pk_fma_f32 v[36:37], v[36:37], s[40:41], v[12:13]
    v_accvgpr_read_b32 v52, a108
    v_accvgpr_read_b32 v53, a109
    v_exp_f32 v254, v254
    v_exp_f32 v255, v255
    v_cvt_pk_bf16_f32 v231, v238, v239
    v_pk_fma_f32 v[38:39], v[38:39], s[40:41], v[12:13]
    v_accvgpr_read_b32 v54, a110
    v_accvgpr_read_b32 v55, a111
    v_exp_f32 v28, v28
    v_exp_f32 v29, v29
    v_cvt_pk_bf16_f32 v244, v244, v245
    v_pk_fma_f32 v[44:45], v[44:45], s[40:41], v[14:15]
    v_accvgpr_read_b32 v60, a112
    v_accvgpr_read_b32 v61, a113
    v_mfma_f32_16x16x32_bf16 a[236:239], a[224:227], v[228:231], a[236:239]
    v_exp_f32 v30, v30
    v_exp_f32 v31, v31
    v_cvt_pk_bf16_f32 v245, v246, v247
    v_pk_fma_f32 v[46:47], v[46:47], s[40:41], v[14:15]
    v_accvgpr_read_b32 v62, a114
    v_accvgpr_read_b32 v63, a115
    v_exp_f32 v36, v36
    v_exp_f32 v37, v37
    v_cvt_pk_bf16_f32 v246, v252, v253
    v_pk_fma_f32 v[52:53], v[52:53], s[40:41], v[14:15]
    v_accvgpr_read_b32 v76, a116
    v_accvgpr_read_b32 v77, a117
    v_exp_f32 v38, v38
    v_exp_f32 v39, v39
    v_cvt_pk_bf16_f32 v247, v254, v255
    v_pk_fma_f32 v[54:55], v[54:55], s[40:41], v[14:15]
    v_accvgpr_read_b32 v78, a118
    v_accvgpr_read_b32 v79, a119
    v_exp_f32 v44, v44
    v_exp_f32 v45, v45
    v_cvt_pk_bf16_f32 v28, v28, v29
    v_pk_fma_f32 v[60:61], v[60:61], s[40:41], v[16:17]
    v_accvgpr_read_b32 v92, a120
    v_accvgpr_read_b32 v93, a121
    v_mfma_f32_16x16x32_bf16 a[240:243], a[224:227], v[244:247], a[240:243]
    v_exp_f32 v46, v46
    v_exp_f32 v47, v47
    v_cvt_pk_bf16_f32 v29, v30, v31
    v_pk_fma_f32 v[62:63], v[62:63], s[40:41], v[16:17]
    v_accvgpr_read_b32 v94, a122
    v_accvgpr_read_b32 v95, a123
    v_exp_f32 v52, v52
    v_exp_f32 v53, v53
    v_cvt_pk_bf16_f32 v30, v36, v37
    v_pk_fma_f32 v[76:77], v[76:77], s[40:41], v[16:17]
    v_accvgpr_read_b32 v108, a124
    v_accvgpr_read_b32 v109, a125
    v_exp_f32 v54, v54
    v_exp_f32 v55, v55
    v_cvt_pk_bf16_f32 v31, v38, v39
    v_pk_fma_f32 v[78:79], v[78:79], s[40:41], v[16:17]
    v_accvgpr_read_b32 v110, a126
    v_accvgpr_read_b32 v111, a127
    v_exp_f32 v60, v60
    v_exp_f32 v61, v61
    v_cvt_pk_bf16_f32 v44, v44, v45
    v_pk_fma_f32 v[92:93], v[92:93], s[40:41], v[12:13]
    v_accvgpr_read_b32 v124, a128
    v_accvgpr_read_b32 v125, a129
    v_mfma_f32_16x16x32_bf16 a[232:235], a[224:227], v[28:31], a[232:235]
    v_exp_f32 v62, v62
    v_exp_f32 v63, v63
    v_cvt_pk_bf16_f32 v45, v46, v47
    v_pk_fma_f32 v[94:95], v[94:95], s[40:41], v[12:13]
    v_accvgpr_read_b32 v126, a130
    v_accvgpr_read_b32 v127, a131
    v_exp_f32 v76, v76
    v_exp_f32 v77, v77
    v_cvt_pk_bf16_f32 v46, v52, v53
    v_pk_fma_f32 v[108:109], v[108:109], s[40:41], v[12:13]
    v_accvgpr_read_b32 v140, a132
    v_accvgpr_read_b32 v141, a133
    v_exp_f32 v78, v78
    v_exp_f32 v79, v79
    v_cvt_pk_bf16_f32 v47, v54, v55
    v_pk_fma_f32 v[110:111], v[110:111], s[40:41], v[12:13]
    v_accvgpr_read_b32 v142, a134
    v_accvgpr_read_b32 v143, a135
    v_lshrrev_b32 v18, 2, v0
    v_and_b32 v19, 6, v18
    v_bfe_u32 v20, v0, 1, 1
    v_xor_b32 v19, v19, v20
    v_lshlrev_b32 v19, 4, v19
    v_and_b32 v20, 1, v0
    v_lshl_add_u32 v19, v20, 3, v19
    v_lshl_add_u32 v5, v18, 7, v19
    s_waitcnt vmcnt(18)
    s_barrier
    v_exp_f32 v92, v92
    ds_read_b64_tr_b16 a[160:161], v5 offset:0
    v_exp_f32 v93, v93
    ds_read_b64_tr_b16 a[162:163], v5 offset:2048
    v_cvt_pk_bf16_f32 v60, v60, v61
    v_pk_fma_f32 v[124:125], v[124:125], s[40:41], v[14:15]
    v_accvgpr_read_b32 v156, a136
    v_accvgpr_read_b32 v157, a137
    v_mfma_f32_16x16x32_bf16 a[236:239], a[224:227], v[44:47], a[236:239]
    v_exp_f32 v94, v94
    ds_read_b64_tr_b16 a[164:165], v5 offset:4096
    v_exp_f32 v95, v95
    ds_read_b64_tr_b16 a[166:167], v5 offset:6144
    v_cvt_pk_bf16_f32 v61, v62, v63
    v_pk_fma_f32 v[126:127], v[126:127], s[40:41], v[14:15]
    v_accvgpr_read_b32 v158, a138
    v_accvgpr_read_b32 v159, a139
    v_exp_f32 v108, v108
    ds_read_b64_tr_b16 a[168:169], v5 offset:8192
    v_exp_f32 v109, v109
    ds_read_b64_tr_b16 a[170:171], v5 offset:10240
    v_cvt_pk_bf16_f32 v62, v76, v77
    v_pk_fma_f32 v[140:141], v[140:141], s[40:41], v[14:15]
    v_accvgpr_read_b32 v172, a140
    v_accvgpr_read_b32 v173, a141
    v_exp_f32 v110, v110
    ds_read_b64_tr_b16 a[172:173], v5 offset:12288
    v_exp_f32 v111, v111
    ds_read_b64_tr_b16 a[174:175], v5 offset:14336
    v_cvt_pk_bf16_f32 v63, v78, v79
    v_pk_fma_f32 v[142:143], v[142:143], s[40:41], v[14:15]
    v_accvgpr_read_b32 v174, a142
    v_accvgpr_read_b32 v175, a143
    v_exp_f32 v124, v124
    ds_read_b64_tr_b16 a[176:177], v5 offset:16384
    v_exp_f32 v125, v125
    ds_read_b64_tr_b16 a[178:179], v5 offset:18432
L_pg5:
    s_cbranch_execz L_warm_done
    v_cvt_pk_bf16_f32 v92, v92, v93
    v_pk_fma_f32 v[156:157], v[156:157], s[40:41], v[16:17]
    v_accvgpr_read_b32 v188, a144
    v_accvgpr_read_b32 v189, a145
    v_mfma_f32_16x16x32_bf16 a[240:243], a[224:227], v[60:63], a[240:243]
    v_exp_f32 v126, v126
    ds_read_b64_tr_b16 a[180:181], v5 offset:20480
    v_exp_f32 v127, v127
    ds_read_b64_tr_b16 a[182:183], v5 offset:22528
    v_cvt_pk_bf16_f32 v93, v94, v95
    v_pk_fma_f32 v[158:159], v[158:159], s[40:41], v[16:17]
    v_accvgpr_read_b32 v190, a146
    v_accvgpr_read_b32 v191, a147
    v_exp_f32 v140, v140
    ds_read_b64_tr_b16 a[184:185], v5 offset:24576
    v_exp_f32 v141, v141
    ds_read_b64_tr_b16 a[186:187], v5 offset:26624
    v_cvt_pk_bf16_f32 v94, v108, v109
    v_pk_fma_f32 v[172:173], v[172:173], s[40:41], v[16:17]
    v_accvgpr_read_b32 v204, a148
    v_accvgpr_read_b32 v205, a149
    v_exp_f32 v142, v142
    ds_read_b64_tr_b16 a[188:189], v5 offset:28672
    v_exp_f32 v143, v143
    ds_read_b64_tr_b16 a[190:191], v5 offset:30720
    v_cvt_pk_bf16_f32 v95, v110, v111
    v_pk_fma_f32 v[174:175], v[174:175], s[40:41], v[16:17]
    v_accvgpr_read_b32 v206, a150
    v_accvgpr_read_b32 v207, a151
    v_exp_f32 v156, v156
    v_exp_f32 v157, v157
    v_cvt_pk_bf16_f32 v124, v124, v125
    v_pk_fma_f32 v[188:189], v[188:189], s[40:41], v[12:13]
    v_mfma_f32_16x16x32_bf16 a[232:235], a[224:227], v[92:95], a[232:235]
    v_exp_f32 v158, v158
    v_exp_f32 v159, v159
    v_cvt_pk_bf16_f32 v125, v126, v127
    v_pk_fma_f32 v[190:191], v[190:191], s[40:41], v[12:13]
    v_exp_f32 v172, v172
    v_exp_f32 v173, v173
    v_cvt_pk_bf16_f32 v126, v140, v141
    v_pk_fma_f32 v[204:205], v[204:205], s[40:41], v[12:13]
    v_exp_f32 v174, v174
    v_exp_f32 v175, v175
    v_cvt_pk_bf16_f32 v127, v142, v143
    v_pk_fma_f32 v[206:207], v[206:207], s[40:41], v[12:13]
    v_exp_f32 v188, v188
    v_exp_f32 v189, v189
    v_cvt_pk_bf16_f32 v156, v156, v157
    v_mfma_f32_16x16x32_bf16 a[236:239], a[224:227], v[124:127], a[236:239]
    v_exp_f32 v190, v190
    v_exp_f32 v191, v191
    v_cvt_pk_bf16_f32 v157, v158, v159
    v_exp_f32 v204, v204
    v_exp_f32 v205, v205
    v_cvt_pk_bf16_f32 v158, v172, v173
    v_exp_f32 v206, v206
    v_exp_f32 v207, v207
    v_cvt_pk_bf16_f32 v159, v174, v175
    v_cvt_pk_bf16_f32 v188, v188, v189
    s_nop 1
    v_mfma_f32_16x16x32_bf16 a[240:243], a[224:227], v[156:159], a[240:243]
    v_cvt_pk_bf16_f32 v189, v190, v191
    v_cvt_pk_bf16_f32 v190, v204, v205
    v_cvt_pk_bf16_f32 v191, v206, v207
    s_nop 1
    v_mfma_f32_16x16x32_bf16 a[232:235], a[224:227], v[188:191], a[232:235]
    s_mul_i32 s99, s22, 0x1b00
    s_add_u32 s99, s99, 0
    v_xor_b32 v5, 32, v5
    s_waitcnt lgkmcnt(12)
    v_mfma_f32_16x16x32_bf16 v[8:11], a[160:163], v[64:67], 0
    s_add_u32 s42, s25, s43
    ds_read_b64_tr_b16 a[192:193], v5 offset:0
    v_mfma_f32_16x16x32_bf16 v[8:11], a[164:167], v[88:91], v[8:11]
    s_waitcnt lgkmcnt(9)
    ds_read_b64_tr_b16 a[194:195], v5 offset:2048
    v_mfma_f32_16x16x32_bf16 v[8:11], a[168:171], v[112:115], v[8:11]
    s_add_u32 m0, s23, 0x10000
    ds_read_b64_tr_b16 a[196:197], v5 offset:4096
    v_mfma_f32_16x16x32_bf16 v[8:11], a[172:175], v[136:139], v[8:11]
    s_waitcnt lgkmcnt(7)
    ds_read_b64_tr_b16 a[198:199], v5 offset:6144
    v_mfma_f32_16x16x32_bf16 v[8:11], a[176:179], v[160:163], v[8:11]
    buffer_load_dwordx4 v1, s[12:15], s42 offen nt lds
    v_mfma_f32_16x16x32_bf16 v[8:11], a[180:183], v[184:187], v[8:11]
    s_waitcnt lgkmcnt(4)
    ds_read_b64_tr_b16 a[200:201], v5 offset:8192
    v_mfma_f32_16x16x32_bf16 v[8:11], a[184:187], v[208:211], v[8:11]
    ds_read_b64_tr_b16 a[202:203], v5 offset:10240
    v_mfma_f32_16x16x32_bf16 v[8:11], a[188:191], v[232:235], v[8:11]
    ds_read_b64_tr_b16 a[204:205], v5 offset:12288
    v_accvgpr_read_b32 v12, a232
    s_waitcnt vmcnt(1)
    v_mfma_f32_16x16x32_bf16 v[20:23], a[160:163], v[72:75], 0
    ds_read_b64_tr_b16 a[206:207], v5 offset:14336
    v_accvgpr_read_b32 v14, a236
    v_mfma_f32_16x16x32_bf16 v[20:23], a[164:167], v[96:99], v[20:23]
    buffer_load_dwordx4 v2, s[12:15], s42 offen offset:1024 nt lds
    v_accvgpr_read_b32 v16, a240
    v_mfma_f32_16x16x32_bf16 v[20:23], a[168:171], v[120:123], v[20:23]
    s_add_u32 s42, s25, s96
    ds_read_b64_tr_b16 a[208:209], v5 offset:16384
    v_rcp_f32 v12, v12
    v_mfma_f32_16x16x32_bf16 v[20:23], a[172:175], v[144:147], v[20:23]
    s_add_u32 m0, s23, 0x12000
    ds_read_b64_tr_b16 a[210:211], v5 offset:18432
    v_rcp_f32 v14, v14
    v_mfma_f32_16x16x32_bf16 v[20:23], a[176:179], v[168:171], v[20:23]
    ds_read_b64_tr_b16 a[212:213], v5 offset:20480
    v_rcp_f32 v16, v16
    v_mfma_f32_16x16x32_bf16 v[20:23], a[180:183], v[192:195], v[20:23]
    ds_read_b64_tr_b16 a[214:215], v5 offset:22528
    v_lshrrev_b32 v13, 3, v0
    v_mfma_f32_16x16x32_bf16 v[20:23], a[184:187], v[216:219], v[20:23]
    buffer_load_dwordx4 v1, s[12:15], s42 offen nt lds
    v_and_b32 v15, 7, v0
    v_mfma_f32_16x16x32_bf16 v[20:23], a[188:191], v[240:243], v[20:23]
    ds_read_b64_tr_b16 a[216:217], v5 offset:24576
    v_lshlrev_b32 v15, 4, v15
    v_mfma_f32_16x16x32_bf16 v[204:207], a[160:163], v[80:83], 0
    ds_read_b64_tr_b16 a[218:219], v5 offset:26624
    v_lshl_add_u32 v7, v13, 9, v15
    v_mfma_f32_16x16x32_bf16 v[204:207], a[164:167], v[104:107], v[204:207]
    ds_read_b64_tr_b16 a[220:221], v5 offset:28672
    v_add_u32 v6, 0x1000, v7
    v_mfma_f32_16x16x32_bf16 v[204:207], a[168:171], v[128:131], v[204:207]
    ds_read_b64_tr_b16 a[222:223], v5 offset:30720
    v_xor_b32 v5, 0x60, v5
    v_mfma_f32_16x16x32_bf16 v[204:207], a[172:175], v[152:155], v[204:207]
    buffer_load_dwordx4 v2, s[12:15], s42 offen offset:1024 nt lds
    v_mul_u32_u24 v13, 0x90, v13
    v_mfma_f32_16x16x32_bf16 v[204:207], a[176:179], v[176:179], v[204:207]
    s_add_u32 s42, s25, s97
    v_add3_u32 v4, v13, v15, s99
    v_and_b32 v13, 15, v0
    v_mfma_f32_16x16x32_bf16 v[204:207], a[180:183], v[200:203], v[204:207]
    s_add_u32 m0, s23, 0x14000
    v_mul_u32_u24 v13, 0x90, v13
    v_lshrrev_b32 v15, 4, v0
    v_mfma_f32_16x16x32_bf16 v[204:207], a[184:187], v[224:227], v[204:207]
    buffer_load_dwordx4 v1, s[12:15], s42 offen nt lds
    v_lshlrev_b32 v15, 3, v15
    v_mfma_f32_16x16x32_bf16 v[204:207], a[188:191], v[248:251], v[204:207]
    s_waitcnt lgkmcnt(12)
    v_add3_u32 v3, v13, v15, s99
    v_mfma_f32_16x16x32_bf16 v[172:175], a[192:195], v[64:67], 0
    ds_read_b64_tr_b16 a[160:161], v5 offset:0
    v_mfma_f32_16x16x32_bf16 v[172:175], a[196:199], v[88:91], v[172:175]
    s_waitcnt lgkmcnt(9)
    ds_read_b64_tr_b16 a[162:163], v5 offset:2048
    v_mfma_f32_16x16x32_bf16 v[172:175], a[200:203], v[112:115], v[172:175]
    ds_read_b64_tr_b16 a[164:165], v5 offset:4096
    v_mfma_f32_16x16x32_bf16 v[172:175], a[204:207], v[136:139], v[172:175]
    s_waitcnt lgkmcnt(7)
    ds_read_b64_tr_b16 a[166:167], v5 offset:6144
    v_mfma_f32_16x16x32_bf16 v[172:175], a[208:211], v[160:163], v[172:175]
    buffer_load_dwordx4 v2, s[12:15], s42 offen offset:1024 nt lds
    v_mfma_f32_16x16x32_bf16 v[172:175], a[212:215], v[184:187], v[172:175]
    s_waitcnt lgkmcnt(4)
    ds_read_b64_tr_b16 a[168:169], v5 offset:8192
    v_mfma_f32_16x16x32_bf16 v[172:175], a[216:219], v[208:211], v[172:175]
    s_add_u32 s42, s25, s98
    ds_read_b64_tr_b16 a[170:171], v5 offset:10240
    v_mfma_f32_16x16x32_bf16 v[172:175], a[220:223], v[232:235], v[172:175]
    s_add_u32 m0, s23, 0x16000
    ds_read_b64_tr_b16 a[172:173], v5 offset:12288
    v_mfma_f32_16x16x32_bf16 v[140:143], a[192:195], v[72:75], 0
    ds_read_b64_tr_b16 a[174:175], v5 offset:14336
    v_mfma_f32_16x16x32_bf16 v[140:143], a[196:199], v[96:99], v[140:143]
    buffer_load_dwordx4 v1, s[12:15], s42 offen nt lds
    v_mfma_f32_16x16x32_bf16 v[140:143], a[200:203], v[120:123], v[140:143]
    ds_read_b64_tr_b16 a[176:177], v5 offset:16384
    v_mfma_f32_16x16x32_bf16 v[140:143], a[204:207], v[144:147], v[140:143]
    ds_read_b64_tr_b16 a[178:179], v5 offset:18432
    v_mfma_f32_16x16x32_bf16 v[140:143], a[208:211], v[168:171], v[140:143]
    ds_read_b64_tr_b16 a[180:181], v5 offset:20480
    v_mfma_f32_16x16x32_bf16 v[140:143], a[212:215], v[192:195], v[140:143]
    ds_read_b64_tr_b16 a[182:183], v5 offset:22528
    v_mfma_f32_16x16x32_bf16 v[140:143], a[216:219], v[216:219], v[140:143]
    buffer_load_dwordx4 v2, s[12:15], s42 offen offset:1024 nt lds
    v_mfma_f32_16x16x32_bf16 v[140:143], a[220:223], v[240:243], v[140:143]
    s_add_u32 s42, s26, s43
    ds_read_b64_tr_b16 a[184:185], v5 offset:24576
    v_mfma_f32_16x16x32_bf16 v[108:111], a[192:195], v[80:83], 0
    s_add_u32 s42, s42, 0x20000
    ds_read_b64_tr_b16 a[186:187], v5 offset:26624
    v_mfma_f32_16x16x32_bf16 v[108:111], a[196:199], v[104:107], v[108:111]
    s_add_u32 m0, s23, 0x18000
    ds_read_b64_tr_b16 a[188:189], v5 offset:28672
    v_mfma_f32_16x16x32_bf16 v[108:111], a[200:203], v[128:131], v[108:111]
    ds_read_b64_tr_b16 a[190:191], v5 offset:30720
    v_xor_b32 v5, 32, v5
    v_mfma_f32_16x16x32_bf16 v[108:111], a[204:207], v[152:155], v[108:111]
    buffer_load_dwordx4 v1, s[12:15], s42 offen nt lds
    v_mfma_f32_16x16x32_bf16 v[108:111], a[208:211], v[176:179], v[108:111]
    v_mfma_f32_16x16x32_bf16 v[108:111], a[212:215], v[200:203], v[108:111]
    buffer_load_dwordx4 v2, s[12:15], s42 offen offset:1024 nt lds
    v_mfma_f32_16x16x32_bf16 v[108:111], a[216:219], v[224:227], v[108:111]
    s_add_u32 s42, s26, s96
    v_mfma_f32_16x16x32_bf16 v[108:111], a[220:223], v[248:251], v[108:111]
    s_waitcnt lgkmcnt(12)
    v_mfma_f32_16x16x32_bf16 v[76:79], a[160:163], v[64:67], 0
    s_add_u32 s42, s42, 0x20000
    ds_read_b64_tr_b16 a[192:193], v5 offset:0
    v_mfma_f32_16x16x32_bf16 v[76:79], a[164:167], v[88:91], v[76:79]
    s_waitcnt lgkmcnt(9)
    ds_read_b64_tr_b16 a[194:195], v5 offset:2048
    v_mfma_f32_16x16x32_bf16 v[76:79], a[168:171], v[112:115], v[76:79]
    s_add_u32 m0, s23, 0x1a000
    ds_read_b64_tr_b16 a[196:197], v5 offset:4096
    v_mfma_f32_16x16x32_bf16 v[76:79], a[172:175], v[136:139], v[76:79]
    s_waitcnt lgkmcnt(7)
    ds_read_b64_tr_b16 a[198:199], v5 offset:6144
    v_mfma_f32_16x16x32_bf16 v[76:79], a[176:179], v[160:163], v[76:79]
    buffer_load_dwordx4 v1, s[12:15], s42 offen nt lds
    v_mfma_f32_16x16x32_bf16 v[76:79], a[180:183], v[184:187], v[76:79]
    s_waitcnt lgkmcnt(4)
    ds_read_b64_tr_b16 a[200:201], v5 offset:8192
    v_mfma_f32_16x16x32_bf16 v[76:79], a[184:187], v[208:211], v[76:79]
    ds_read_b64_tr_b16 a[202:203], v5 offset:10240
    v_mfma_f32_16x16x32_bf16 v[76:79], a[188:191], v[232:235], v[76:79]
    ds_read_b64_tr_b16 a[204:205], v5 offset:12288
    v_mfma_f32_16x16x32_bf16 v[52:55], a[160:163], v[72:75], 0
    ds_read_b64_tr_b16 a[206:207], v5 offset:14336
    v_mfma_f32_16x16x32_bf16 v[52:55], a[164:167], v[96:99], v[52:55]
    buffer_load_dwordx4 v2, s[12:15], s42 offen offset:1024 nt lds
    v_mfma_f32_16x16x32_bf16 v[52:55], a[168:171], v[120:123], v[52:55]
    s_add_u32 s42, s26, s97
    ds_read_b64_tr_b16 a[208:209], v5 offset:16384
    v_mfma_f32_16x16x32_bf16 v[52:55], a[172:175], v[144:147], v[52:55]
    s_add_u32 s42, s42, 0x20000
    ds_read_b64_tr_b16 a[210:211], v5 offset:18432
    v_mfma_f32_16x16x32_bf16 v[52:55], a[176:179], v[168:171], v[52:55]
    s_add_u32 m0, s23, 0x1c000
    ds_read_b64_tr_b16 a[212:213], v5 offset:20480
    v_mfma_f32_16x16x32_bf16 v[52:55], a[180:183], v[192:195], v[52:55]
    ds_read_b64_tr_b16 a[214:215], v5 offset:22528
    v_mfma_f32_16x16x32_bf16 v[52:55], a[184:187], v[216:219], v[52:55]
    buffer_load_dwordx4 v1, s[12:15], s42 offen nt lds
    v_mfma_f32_16x16x32_bf16 v[52:55], a[188:191], v[240:243], v[52:55]
    ds_read_b64_tr_b16 a[216:217], v5 offset:24576
    v_mfma_f32_16x16x32_bf16 v[36:39], a[160:163], v[80:83], 0
    ds_read_b64_tr_b16 a[218:219], v5 offset:26624
    v_mfma_f32_16x16x32_bf16 v[36:39], a[164:167], v[104:107], v[36:39]
    ds_read_b64_tr_b16 a[220:221], v5 offset:28672
    v_mfma_f32_16x16x32_bf16 v[36:39], a[168:171], v[128:131], v[36:39]
    ds_read_b64_tr_b16 a[222:223], v5 offset:30720
    v_xor_b32 v5, 0x60, v5
    v_mfma_f32_16x16x32_bf16 v[36:39], a[172:175], v[152:155], v[36:39]
    buffer_load_dwordx4 v2, s[12:15], s42 offen offset:1024 nt lds
    v_mfma_f32_16x16x32_bf16 v[36:39], a[176:179], v[176:179], v[36:39]
    s_add_u32 s42, s26, s98
    v_mfma_f32_16x16x32_bf16 v[36:39], a[180:183], v[200:203], v[36:39]
    s_add_u32 s42, s42, 0x20000
    v_mfma_f32_16x16x32_bf16 v[36:39], a[184:187], v[224:227], v[36:39]
    s_add_u32 m0, s23, 0x1e000
    v_mfma_f32_16x16x32_bf16 v[36:39], a[188:191], v[248:251], v[36:39]
    s_waitcnt lgkmcnt(12)
    buffer_load_dwordx4 v1, s[12:15], s42 offen nt lds
    v_mfma_f32_16x16x32_bf16 v[252:255], a[192:195], v[64:67], 0
    s_barrier
    ds_read_b64_tr_b16 a[160:161], v5 offset:32768
    v_mfma_f32_16x16x32_bf16 v[252:255], a[196:199], v[88:91], v[252:255]
    s_waitcnt lgkmcnt(9)
    ds_read_b64_tr_b16 a[162:163], v5 offset:34816
    v_mfma_f32_16x16x32_bf16 v[252:255], a[200:203], v[112:115], v[252:255]
    ds_read_b64_tr_b16 a[164:165], v5 offset:36864
    v_mfma_f32_16x16x32_bf16 v[252:255], a[204:207], v[136:139], v[252:255]
    s_waitcnt lgkmcnt(7)
    ds_read_b64_tr_b16 a[166:167], v5 offset:38912
    v_mfma_f32_16x16x32_bf16 v[252:255], a[208:211], v[160:163], v[252:255]
    buffer_load_dwordx4 v2, s[12:15], s42 offen offset:1024 nt lds
    v_mfma_f32_16x16x32_bf16 v[252:255], a[212:215], v[184:187], v[252:255]
    s_waitcnt lgkmcnt(4)
    ds_read_b64_tr_b16 a[168:169], v5 offset:40960
    v_mfma_f32_16x16x32_bf16 v[252:255], a[216:219], v[208:211], v[252:255]
    ds_read_b64_tr_b16 a[170:171], v5 offset:43008
    v_mfma_f32_16x16x32_bf16 v[252:255], a[220:223], v[232:235], v[252:255]
    ds_read_b64_tr_b16 a[172:173], v5 offset:45056
    v_mfma_f32_16x16x32_bf16 v[236:239], a[192:195], v[72:75], 0
    ds_read_b64_tr_b16 a[174:175], v5 offset:47104
    v_mfma_f32_16x16x32_bf16 v[236:239], a[196:199], v[96:99], v[236:239]
    ds_read_b64_tr_b16 a[176:177], v5 offset:49152
    v_mfma_f32_16x16x32_bf16 v[236:239], a[200:203], v[120:123], v[236:239]
    ds_read_b64_tr_b16 a[178:179], v5 offset:51200
    v_mfma_f32_16x16x32_bf16 v[236:239], a[204:207], v[144:147], v[236:239]
    ds_read_b64_tr_b16 a[180:181], v5 offset:53248
    v_mfma_f32_16x16x32_bf16 v[236:239], a[208:211], v[168:171], v[236:239]
    ds_read_b64_tr_b16 a[182:183], v5 offset:55296
    v_mfma_f32_16x16x32_bf16 v[236:239], a[212:215], v[192:195], v[236:239]
    ds_read_b64_tr_b16 a[184:185], v5 offset:57344
    v_mfma_f32_16x16x32_bf16 v[236:239], a[216:219], v[216:219], v[236:239]
    ds_read_b64_tr_b16 a[186:187], v5 offset:59392
    v_mfma_f32_16x16x32_bf16 v[236:239], a[220:223], v[240:243], v[236:239]
    ds_read_b64_tr_b16 a[188:189], v5 offset:61440
    v_mfma_f32_16x16x32_bf16 v[220:223], a[192:195], v[80:83], 0
    ds_read_b64_tr_b16 a[190:191], v5 offset:63488
    v_xor_b32 v5, 32, v5
    v_mfma_f32_16x16x32_bf16 v[220:223], a[196:199], v[104:107], v[220:223]
    v_mfma_f32_16x16x32_bf16 v[220:223], a[200:203], v[128:131], v[220:223]
    v_mfma_f32_16x16x32_bf16 v[220:223], a[204:207], v[152:155], v[220:223]
    v_mfma_f32_16x16x32_bf16 v[220:223], a[208:211], v[176:179], v[220:223]
    v_mfma_f32_16x16x32_bf16 v[220:223], a[212:215], v[200:203], v[220:223]
    v_mfma_f32_16x16x32_bf16 v[220:223], a[216:219], v[224:227], v[220:223]
    v_mfma_f32_16x16x32_bf16 v[220:223], a[220:223], v[248:251], v[220:223]
    s_waitcnt lgkmcnt(12)
    v_mfma_f32_16x16x32_bf16 v[8:11], a[160:163], v[68:71], v[8:11]
    s_barrier
    ds_read_b64_tr_b16 a[192:193], v5 offset:32768
    v_mfma_f32_16x16x32_bf16 v[8:11], a[164:167], v[116:119], v[8:11]
    s_waitcnt lgkmcnt(9)
    ds_read_b64_tr_b16 a[194:195], v5 offset:34816
    v_mfma_f32_16x16x32_bf16 v[8:11], a[168:171], v[164:167], v[8:11]
    ds_read_b64_tr_b16 a[196:197], v5 offset:36864
    v_mfma_f32_16x16x32_bf16 v[8:11], a[172:175], v[212:215], v[8:11]
    s_waitcnt lgkmcnt(7)
    ds_read_b64_tr_b16 a[198:199], v5 offset:38912
    v_mfma_f32_16x16x32_bf16 v[8:11], a[176:179], v[28:31], v[8:11]
    ds_read_b64_tr_b16 a[200:201], v5 offset:40960
    v_mfma_f32_16x16x32_bf16 v[8:11], a[180:183], v[92:95], v[8:11]
    s_waitcnt lgkmcnt(5)
    ds_read_b64_tr_b16 a[202:203], v5 offset:43008
    v_mfma_f32_16x16x32_bf16 v[8:11], a[184:187], v[188:191], v[8:11]
    ds_read_b64_tr_b16 a[204:205], v5 offset:45056
    v_mfma_f32_16x16x32_bf16 v[8:11], a[188:191], v[40:43], v[8:11]
    ds_read_b64_tr_b16 a[206:207], v5 offset:47104
    v_mfma_f32_16x16x32_bf16 v[20:23], a[160:163], v[84:87], v[20:23]
    ds_read_b64_tr_b16 a[208:209], v5 offset:49152
    v_mfma_f32_16x16x32_bf16 v[20:23], a[164:167], v[132:135], v[20:23]
    ds_read_b64_tr_b16 a[210:211], v5 offset:51200
    v_mfma_f32_16x16x32_bf16 v[20:23], a[168:171], v[180:183], v[20:23]
    ds_read_b64_tr_b16 a[212:213], v5 offset:53248
    v_mfma_f32_16x16x32_bf16 v[20:23], a[172:175], v[228:231], v[20:23]
    ds_read_b64_tr_b16 a[214:215], v5 offset:55296
    v_mfma_f32_16x16x32_bf16 v[20:23], a[176:179], v[44:47], v[20:23]
    ds_read_b64_tr_b16 a[216:217], v5 offset:57344
    v_mfma_f32_16x16x32_bf16 v[20:23], a[180:183], v[124:127], v[20:23]
    ds_read_b64_tr_b16 a[218:219], v5 offset:59392
    v_mul_f32 v8, v8, v12
    v_mfma_f32_16x16x32_bf16 v[20:23], a[184:187], v[24:27], v[20:23]
    ds_read_b64_tr_b16 a[220:221], v5 offset:61440
    v_mul_f32 v9, v9, v12
    v_mfma_f32_16x16x32_bf16 v[20:23], a[188:191], v[48:51], v[20:23]
    ds_read_b64_tr_b16 a[222:223], v5 offset:63488
    v_xor_b32 v5, 0x60, v5
    v_mfma_f32_16x16x32_bf16 v[204:207], a[160:163], v[100:103], v[204:207]
    v_mul_f32 v10, v10, v12
    v_mul_f32 v11, v11, v12
    v_mfma_f32_16x16x32_bf16 v[204:207], a[164:167], v[148:151], v[204:207]
    v_cvt_pk_bf16_f32 v8, v8, v9
    v_cvt_pk_bf16_f32 v9, v10, v11
    v_mfma_f32_16x16x32_bf16 v[204:207], a[168:171], v[196:199], v[204:207]
    ds_write_b64 v3, v[8:9] offset:0
    v_mfma_f32_16x16x32_bf16 v[204:207], a[172:175], v[244:247], v[204:207]
    v_mfma_f32_16x16x32_bf16 v[204:207], a[176:179], v[60:63], v[204:207]
    v_mfma_f32_16x16x32_bf16 v[204:207], a[180:183], v[156:159], v[204:207]
    v_mul_f32 v20, v20, v14
    v_mul_f32 v21, v21, v14
    v_mfma_f32_16x16x32_bf16 v[204:207], a[184:187], v[32:35], v[204:207]
    v_mul_f32 v22, v22, v14
    v_mul_f32 v23, v23, v14
    v_mfma_f32_16x16x32_bf16 v[204:207], a[188:191], v[56:59], v[204:207]
    s_waitcnt lgkmcnt(13)
    v_cvt_pk_bf16_f32 v20, v20, v21
    v_cvt_pk_bf16_f32 v21, v22, v23
    v_mfma_f32_16x16x32_bf16 v[172:175], a[192:195], v[68:71], v[172:175]
    ds_read_b64_tr_b16 a[160:161], v5 offset:32768
    v_mfma_f32_16x16x32_bf16 v[172:175], a[196:199], v[116:119], v[172:175]
    s_waitcnt lgkmcnt(10)
    ds_read_b64_tr_b16 a[162:163], v5 offset:34816
    v_mfma_f32_16x16x32_bf16 v[172:175], a[200:203], v[164:167], v[172:175]
    ds_read_b64_tr_b16 a[164:165], v5 offset:36864
    v_mfma_f32_16x16x32_bf16 v[172:175], a[204:207], v[212:215], v[172:175]
    s_waitcnt lgkmcnt(8)
    ds_read_b64_tr_b16 a[166:167], v5 offset:38912
    v_mfma_f32_16x16x32_bf16 v[172:175], a[208:211], v[28:31], v[172:175]
    ds_write_b64 v3, v[20:21] offset:2304
    v_mfma_f32_16x16x32_bf16 v[172:175], a[212:215], v[92:95], v[172:175]
    s_waitcnt lgkmcnt(6)
    ds_read_b64_tr_b16 a[168:169], v5 offset:40960
    v_mul_f32 v204, v204, v16
    v_mfma_f32_16x16x32_bf16 v[172:175], a[216:219], v[188:191], v[172:175]
    ds_read_b64_tr_b16 a[170:171], v5 offset:43008
    v_mul_f32 v205, v205, v16
    v_mfma_f32_16x16x32_bf16 v[172:175], a[220:223], v[40:43], v[172:175]
    ds_read_b64_tr_b16 a[172:173], v5 offset:45056
    v_mul_f32 v206, v206, v16
    v_mfma_f32_16x16x32_bf16 v[140:143], a[192:195], v[84:87], v[140:143]
    ds_read_b64_tr_b16 a[174:175], v5 offset:47104
    v_mul_f32 v207, v207, v16
    v_mfma_f32_16x16x32_bf16 v[140:143], a[196:199], v[132:135], v[140:143]
    ds_read_b64_tr_b16 a[176:177], v5 offset:49152
    v_cvt_pk_bf16_f32 v204, v204, v205
    v_mfma_f32_16x16x32_bf16 v[140:143], a[200:203], v[180:183], v[140:143]
    ds_read_b64_tr_b16 a[178:179], v5 offset:51200
    v_cvt_pk_bf16_f32 v205, v206, v207
    v_mfma_f32_16x16x32_bf16 v[140:143], a[204:207], v[228:231], v[140:143]
    ds_read_b64_tr_b16 a[180:181], v5 offset:53248
    v_mfma_f32_16x16x32_bf16 v[140:143], a[208:211], v[44:47], v[140:143]
    ds_read_b64_tr_b16 a[182:183], v5 offset:55296
    v_mfma_f32_16x16x32_bf16 v[140:143], a[212:215], v[124:127], v[140:143]
    ds_read_b64_tr_b16 a[184:185], v5 offset:57344
    v_mfma_f32_16x16x32_bf16 v[140:143], a[216:219], v[24:27], v[140:143]
    ds_write_b64 v3, v[204:205] offset:4608
    v_mfma_f32_16x16x32_bf16 v[140:143], a[220:223], v[48:51], v[140:143]
    ds_read_b64_tr_b16 a[186:187], v5 offset:59392
    v_mul_f32 v172, v172, v12
    v_mfma_f32_16x16x32_bf16 v[108:111], a[192:195], v[100:103], v[108:111]
    ds_read_b64_tr_b16 a[188:189], v5 offset:61440
    v_mul_f32 v173, v173, v12
    v_mfma_f32_16x16x32_bf16 v[108:111], a[196:199], v[148:151], v[108:111]
    ds_read_b64_tr_b16 a[190:191], v5 offset:63488
    v_xor_b32 v5, 32, v5
    v_mfma_f32_16x16x32_bf16 v[108:111], a[200:203], v[196:199], v[108:111]
    v_mul_f32 v174, v174, v12
    v_mul_f32 v175, v175, v12
    v_mfma_f32_16x16x32_bf16 v[108:111], a[204:207], v[244:247], v[108:111]
    v_cvt_pk_bf16_f32 v172, v172, v173
    v_cvt_pk_bf16_f32 v173, v174, v175
    v_mfma_f32_16x16x32_bf16 v[108:111], a[208:211], v[60:63], v[108:111]
    ds_write_b64 v3, v[172:173] offset:32
    v_mfma_f32_16x16x32_bf16 v[108:111], a[212:215], v[156:159], v[108:111]
    v_mul_f32 v140, v140, v14
    v_mul_f32 v141, v141, v14
    v_mfma_f32_16x16x32_bf16 v[108:111], a[216:219], v[32:35], v[108:111]
    v_mul_f32 v142, v142, v14
    v_mul_f32 v143, v143, v14
    v_mfma_f32_16x16x32_bf16 v[108:111], a[220:223], v[56:59], v[108:111]
    s_waitcnt lgkmcnt(15)
    v_cvt_pk_bf16_f32 v140, v140, v141
    v_cvt_pk_bf16_f32 v141, v142, v143
    v_mfma_f32_16x16x32_bf16 v[76:79], a[160:163], v[68:71], v[76:79]
    ds_read_b64_tr_b16 a[192:193], v5 offset:32768
    v_mfma_f32_16x16x32_bf16 v[76:79], a[164:167], v[116:119], v[76:79]
    s_waitcnt lgkmcnt(11)
    ds_read_b64_tr_b16 a[194:195], v5 offset:34816
    v_mfma_f32_16x16x32_bf16 v[76:79], a[168:171], v[164:167], v[76:79]
    ds_read_b64_tr_b16 a[196:197], v5 offset:36864
    v_mfma_f32_16x16x32_bf16 v[76:79], a[172:175], v[212:215], v[76:79]
    s_waitcnt lgkmcnt(9)
    ds_read_b64_tr_b16 a[198:199], v5 offset:38912
    v_mfma_f32_16x16x32_bf16 v[76:79], a[176:179], v[28:31], v[76:79]
    ds_write_b64 v3, v[140:141] offset:2336
    v_mfma_f32_16x16x32_bf16 v[76:79], a[180:183], v[92:95], v[76:79]
    s_waitcnt lgkmcnt(6)
    ds_read_b64_tr_b16 a[200:201], v5 offset:40960
    v_mul_f32 v108, v108, v16
    v_mfma_f32_16x16x32_bf16 v[76:79], a[184:187], v[188:191], v[76:79]
    ds_read_b64_tr_b16 a[202:203], v5 offset:43008
    v_mul_f32 v109, v109, v16
    v_mfma_f32_16x16x32_bf16 v[76:79], a[188:191], v[40:43], v[76:79]
    ds_read_b64_tr_b16 a[204:205], v5 offset:45056
    v_mul_f32 v110, v110, v16
    v_mfma_f32_16x16x32_bf16 v[52:55], a[160:163], v[84:87], v[52:55]
    ds_read_b64_tr_b16 a[206:207], v5 offset:47104
    v_mul_f32 v111, v111, v16
    v_mfma_f32_16x16x32_bf16 v[52:55], a[164:167], v[132:135], v[52:55]
    ds_read_b64_tr_b16 a[208:209], v5 offset:49152
    v_cvt_pk_bf16_f32 v108, v108, v109
    v_mfma_f32_16x16x32_bf16 v[52:55], a[168:171], v[180:183], v[52:55]
    ds_read_b64_tr_b16 a[210:211], v5 offset:51200
    v_cvt_pk_bf16_f32 v109, v110, v111
    v_mfma_f32_16x16x32_bf16 v[52:55], a[172:175], v[228:231], v[52:55]
    ds_read_b64_tr_b16 a[212:213], v5 offset:53248
    v_mfma_f32_16x16x32_bf16 v[52:55], a[176:179], v[44:47], v[52:55]
    ds_read_b64_tr_b16 a[214:215], v5 offset:55296
    v_mfma_f32_16x16x32_bf16 v[52:55], a[180:183], v[124:127], v[52:55]
    ds_read_b64_tr_b16 a[216:217], v5 offset:57344
    v_mfma_f32_16x16x32_bf16 v[52:55], a[184:187], v[24:27], v[52:55]
    ds_write_b64 v3, v[108:109] offset:4640
    v_mfma_f32_16x16x32_bf16 v[52:55], a[188:191], v[48:51], v[52:55]
    ds_read_b64_tr_b16 a[218:219], v5 offset:59392
    v_mul_f32 v76, v76, v12
    v_mfma_f32_16x16x32_bf16 v[36:39], a[160:163], v[100:103], v[36:39]
    ds_read_b64_tr_b16 a[220:221], v5 offset:61440
    v_mul_f32 v77, v77, v12
    v_mfma_f32_16x16x32_bf16 v[36:39], a[164:167], v[148:151], v[36:39]
    ds_read_b64_tr_b16 a[222:223], v5 offset:63488
    v_add_u32 v5, 0x20000, v5
    v_mfma_f32_16x16x32_bf16 v[36:39], a[168:171], v[196:199], v[36:39]
    v_xor_b32 v5, 0x60, v5
    v_mul_f32 v78, v78, v12
    v_mfma_f32_16x16x32_bf16 v[36:39], a[172:175], v[244:247], v[36:39]
    v_mul_f32 v79, v79, v12
    v_cvt_pk_bf16_f32 v76, v76, v77
    v_mfma_f32_16x16x32_bf16 v[36:39], a[176:179], v[60:63], v[36:39]
    v_cvt_pk_bf16_f32 v77, v78, v79
    v_mfma_f32_16x16x32_bf16 v[36:39], a[180:183], v[156:159], v[36:39]
    ds_write_b64 v3, v[76:77] offset:64
    v_mfma_f32_16x16x32_bf16 v[36:39], a[184:187], v[32:35], v[36:39]
    v_mul_f32 v52, v52, v14
    v_mul_f32 v53, v53, v14
    v_mfma_f32_16x16x32_bf16 v[36:39], a[188:191], v[56:59], v[36:39]
    s_waitcnt lgkmcnt(15)
    v_mul_f32 v54, v54, v14
    v_mul_f32 v55, v55, v14
    v_mfma_f32_16x16x32_bf16 v[252:255], a[192:195], v[68:71], v[252:255]
    s_barrier
    ds_read_b64_tr_b16 a[160:161], v5 offset:0
    v_cvt_pk_bf16_f32 v52, v52, v53
    v_mfma_f32_16x16x32_bf16 v[252:255], a[196:199], v[116:119], v[252:255]
    s_waitcnt lgkmcnt(11)
    ds_read_b64_tr_b16 a[162:163], v5 offset:2048
    v_cvt_pk_bf16_f32 v53, v54, v55
    v_mfma_f32_16x16x32_bf16 v[252:255], a[200:203], v[164:167], v[252:255]
    ds_read_b64_tr_b16 a[164:165], v5 offset:4096
    v_mfma_f32_16x16x32_bf16 v[252:255], a[204:207], v[212:215], v[252:255]
    s_waitcnt lgkmcnt(9)
    ds_read_b64_tr_b16 a[166:167], v5 offset:6144
    v_mfma_f32_16x16x32_bf16 v[252:255], a[208:211], v[28:31], v[252:255]
    ds_write_b64 v3, v[52:53] offset:2368
    v_mfma_f32_16x16x32_bf16 v[252:255], a[212:215], v[92:95], v[252:255]
    s_waitcnt lgkmcnt(6)
    ds_read_b64_tr_b16 a[168:169], v5 offset:8192
    v_mul_f32 v36, v36, v16
    v_mfma_f32_16x16x32_bf16 v[252:255], a[216:219], v[188:191], v[252:255]
    ds_read_b64_tr_b16 a[170:171], v5 offset:10240
    v_mul_f32 v37, v37, v16
    v_mfma_f32_16x16x32_bf16 v[252:255], a[220:223], v[40:43], v[252:255]
    ds_read_b64_tr_b16 a[172:173], v5 offset:12288
    v_mul_f32 v38, v38, v16
    v_mfma_f32_16x16x32_bf16 v[236:239], a[192:195], v[84:87], v[236:239]
    ds_read_b64_tr_b16 a[174:175], v5 offset:14336
    v_mul_f32 v39, v39, v16
    v_mfma_f32_16x16x32_bf16 v[236:239], a[196:199], v[132:135], v[236:239]
    ds_read_b64_tr_b16 a[176:177], v5 offset:16384
    v_cvt_pk_bf16_f32 v36, v36, v37
    v_mfma_f32_16x16x32_bf16 v[236:239], a[200:203], v[180:183], v[236:239]
    ds_read_b64_tr_b16 a[178:179], v5 offset:18432
    v_cvt_pk_bf16_f32 v37, v38, v39
    v_mfma_f32_16x16x32_bf16 v[236:239], a[204:207], v[228:231], v[236:239]
    ds_read_b64_tr_b16 a[180:181], v5 offset:20480
    v_mfma_f32_16x16x32_bf16 v[236:239], a[208:211], v[44:47], v[236:239]
    ds_read_b64_tr_b16 a[182:183], v5 offset:22528
    v_mfma_f32_16x16x32_bf16 v[236:239], a[212:215], v[124:127], v[236:239]
    ds_read_b64_tr_b16 a[184:185], v5 offset:24576
    v_mfma_f32_16x16x32_bf16 v[236:239], a[216:219], v[24:27], v[236:239]
    ds_write_b64 v3, v[36:37] offset:4672
    v_mfma_f32_16x16x32_bf16 v[236:239], a[220:223], v[48:51], v[236:239]
    ds_read_b64_tr_b16 a[186:187], v5 offset:26624
    v_mul_f32 v252, v252, v12
    v_mfma_f32_16x16x32_bf16 v[220:223], a[192:195], v[100:103], v[220:223]
    ds_read_b64_tr_b16 a[188:189], v5 offset:28672
    v_mul_f32 v253, v253, v12
    v_mfma_f32_16x16x32_bf16 v[220:223], a[196:199], v[148:151], v[220:223]
    ds_read_b64_tr_b16 a[190:191], v5 offset:30720
    v_xor_b32 v5, 32, v5
    v_mfma_f32_16x16x32_bf16 v[220:223], a[200:203], v[196:199], v[220:223]
    v_mul_f32 v254, v254, v12
    v_mul_f32 v255, v255, v12
    v_mfma_f32_16x16x32_bf16 v[220:223], a[204:207], v[244:247], v[220:223]
    v_cvt_pk_bf16_f32 v252, v252, v253
    v_cvt_pk_bf16_f32 v253, v254, v255
    v_mfma_f32_16x16x32_bf16 v[220:223], a[208:211], v[60:63], v[220:223]
    ds_write_b64 v3, v[252:253] offset:96
    v_mfma_f32_16x16x32_bf16 v[220:223], a[212:215], v[156:159], v[220:223]
    ds_read_b128 a[64:67], v4 offset:0
    v_mfma_f32_16x16x32_bf16 v[220:223], a[216:219], v[32:35], v[220:223]
    ds_read_b128 a[68:71], v4 offset:1152
    v_mul_f32 v236, v236, v14
    v_mfma_f32_16x16x32_bf16 v[220:223], a[220:223], v[56:59], v[220:223]
    s_waitcnt lgkmcnt(15)
    v_mul_f32 v237, v237, v14
    v_mul_f32 v238, v238, v14
    v_mfma_f32_16x16x32_bf16 v[8:11], a[160:163], v[64:67], 0
    ds_read_b64_tr_b16 a[192:193], v5 offset:0
    v_mul_f32 v239, v239, v14
    v_mfma_f32_16x16x32_bf16 v[8:11], a[164:167], v[88:91], v[8:11]
    s_waitcnt lgkmcnt(13)
    ds_read_b64_tr_b16 a[194:195], v5 offset:2048
    v_cvt_pk_bf16_f32 v236, v236, v237
    v_mfma_f32_16x16x32_bf16 v[8:11], a[168:171], v[112:115], v[8:11]
    ds_read_b64_tr_b16 a[196:197], v5 offset:4096
    v_cvt_pk_bf16_f32 v237, v238, v239
    v_mfma_f32_16x16x32_bf16 v[8:11], a[172:175], v[136:139], v[8:11]
L_pg6:
    s_cbranch_execz L_warm_done
    s_waitcnt lgkmcnt(11)
    ds_read_b64_tr_b16 a[198:199], v5 offset:6144
    v_mfma_f32_16x16x32_bf16 v[8:11], a[176:179], v[160:163], v[8:11]
    ds_write_b64 v3, v[236:237] offset:2400
    v_mfma_f32_16x16x32_bf16 v[8:11], a[180:183], v[184:187], v[8:11]
    s_waitcnt lgkmcnt(8)
    ds_read_b64_tr_b16 a[200:201], v5 offset:8192
    v_mfma_f32_16x16x32_bf16 v[8:11], a[184:187], v[208:211], v[8:11]
    ds_read_b64_tr_b16 a[202:203], v5 offset:10240
    v_mfma_f32_16x16x32_bf16 v[8:11], a[188:191], v[232:235], v[8:11]
    ds_read_b64_tr_b16 a[204:205], v5 offset:12288
    v_mfma_f32_16x16x32_bf16 v[20:23], a[160:163], v[72:75], 0
    ds_read_b64_tr_b16 a[206:207], v5 offset:14336
    v_mfma_f32_16x16x32_bf16 v[20:23], a[164:167], v[96:99], v[20:23]
    ds_read_b128 a[72:75], v4 offset:2304
    v_mfma_f32_16x16x32_bf16 v[20:23], a[168:171], v[120:123], v[20:23]
    ds_read_b64_tr_b16 a[208:209], v5 offset:16384
    v_mfma_f32_16x16x32_bf16 v[20:23], a[172:175], v[144:147], v[20:23]
    ds_read_b64_tr_b16 a[210:211], v5 offset:18432
    v_mfma_f32_16x16x32_bf16 v[20:23], a[176:179], v[168:171], v[20:23]
    ds_read_b64_tr_b16 a[212:213], v5 offset:20480
    v_mfma_f32_16x16x32_bf16 v[20:23], a[180:183], v[192:195], v[20:23]
    ds_read_b64_tr_b16 a[214:215], v5 offset:22528
    v_mfma_f32_16x16x32_bf16 v[20:23], a[184:187], v[216:219], v[20:23]
    ds_read_b128 a[76:79], v4 offset:3456
    v_mul_f32 v220, v220, v16
    v_mfma_f32_16x16x32_bf16 v[20:23], a[188:191], v[240:243], v[20:23]
    ds_read_b64_tr_b16 a[216:217], v5 offset:24576
    v_mul_f32 v221, v221, v16
    v_mfma_f32_16x16x32_bf16 v[204:207], a[160:163], v[80:83], 0
    ds_read_b64_tr_b16 a[218:219], v5 offset:26624
    v_mul_f32 v222, v222, v16
    v_mfma_f32_16x16x32_bf16 v[204:207], a[164:167], v[104:107], v[204:207]
    ds_read_b64_tr_b16 a[220:221], v5 offset:28672
    v_mul_f32 v223, v223, v16
    v_mfma_f32_16x16x32_bf16 v[204:207], a[168:171], v[128:131], v[204:207]
    ds_read_b64_tr_b16 a[222:223], v5 offset:30720
    v_xor_b32 v5, 0x60, v5
    v_mfma_f32_16x16x32_bf16 v[204:207], a[172:175], v[152:155], v[204:207]
    v_cvt_pk_bf16_f32 v220, v220, v221
    v_cvt_pk_bf16_f32 v221, v222, v223
    v_mfma_f32_16x16x32_bf16 v[204:207], a[176:179], v[176:179], v[204:207]
    ds_write_b64 v3, v[220:221] offset:4704
    v_mfma_f32_16x16x32_bf16 v[204:207], a[180:183], v[200:203], v[204:207]
    ds_read_b128 a[80:83], v4 offset:4608
    v_mfma_f32_16x16x32_bf16 v[204:207], a[184:187], v[224:227], v[204:207]
    ds_read_b128 a[84:87], v4 offset:5760
    v_mfma_f32_16x16x32_bf16 v[204:207], a[188:191], v[248:251], v[204:207]
    s_waitcnt lgkmcnt(15)
    v_mfma_f32_16x16x32_bf16 v[172:175], a[192:195], v[64:67], 0
    ds_read_b64_tr_b16 a[160:161], v5 offset:0
    v_mfma_f32_16x16x32_bf16 v[172:175], a[196:199], v[88:91], v[172:175]
    s_waitcnt lgkmcnt(14)
    ds_read_b64_tr_b16 a[162:163], v5 offset:2048
    v_mfma_f32_16x16x32_bf16 v[172:175], a[200:203], v[112:115], v[172:175]
    ds_read_b64_tr_b16 a[164:165], v5 offset:4096
    v_mfma_f32_16x16x32_bf16 v[172:175], a[204:207], v[136:139], v[172:175]
    s_waitcnt lgkmcnt(11)
    ds_read_b64_tr_b16 a[166:167], v5 offset:6144
    v_mfma_f32_16x16x32_bf16 v[172:175], a[208:211], v[160:163], v[172:175]
    ds_read_b64_tr_b16 a[168:169], v5 offset:8192
    v_mfma_f32_16x16x32_bf16 v[172:175], a[212:215], v[184:187], v[172:175]
    s_waitcnt lgkmcnt(8)
    ds_read_b64_tr_b16 a[170:171], v5 offset:10240
    v_mfma_f32_16x16x32_bf16 v[172:175], a[216:219], v[208:211], v[172:175]
    ds_read_b64_tr_b16 a[172:173], v5 offset:12288
    v_mfma_f32_16x16x32_bf16 v[172:175], a[220:223], v[232:235], v[172:175]
    ds_read_b64_tr_b16 a[174:175], v5 offset:14336
    v_mfma_f32_16x16x32_bf16 v[140:143], a[192:195], v[72:75], 0
    s_waitcnt lgkmcnt(8)
    s_barrier
    ds_read_b64_tr_b16 a[176:177], v5 offset:16384
    v_mfma_f32_16x16x32_bf16 v[140:143], a[196:199], v[96:99], v[140:143]
    s_add_u32 s42, s26, s43
    ds_read_b64_tr_b16 a[178:179], v5 offset:18432
    v_mfma_f32_16x16x32_bf16 v[140:143], a[200:203], v[120:123], v[140:143]
    s_add_u32 m0, s23, 0
    ds_read_b64_tr_b16 a[180:181], v5 offset:20480
    v_mfma_f32_16x16x32_bf16 v[140:143], a[204:207], v[144:147], v[140:143]
    ds_read_b64_tr_b16 a[182:183], v5 offset:22528
    v_mfma_f32_16x16x32_bf16 v[140:143], a[208:211], v[168:171], v[140:143]
    ds_read_b64_tr_b16 a[184:185], v5 offset:24576
    v_mfma_f32_16x16x32_bf16 v[140:143], a[212:215], v[192:195], v[140:143]
    ds_read_b64_tr_b16 a[186:187], v5 offset:26624
    v_mfma_f32_16x16x32_bf16 v[140:143], a[216:219], v[216:219], v[140:143]
    buffer_load_dwordx4 v1, s[12:15], s42 offen nt lds
    v_mfma_f32_16x16x32_bf16 v[140:143], a[220:223], v[240:243], v[140:143]
    ds_read_b64_tr_b16 a[188:189], v5 offset:28672
    v_mfma_f32_16x16x32_bf16 v[108:111], a[192:195], v[80:83], 0
    ds_read_b64_tr_b16 a[190:191], v5 offset:30720
    v_xor_b32 v5, 32, v5
    v_mfma_f32_16x16x32_bf16 v[108:111], a[196:199], v[104:107], v[108:111]
    buffer_load_dwordx4 v2, s[12:15], s42 offen offset:1024 nt lds
    v_mfma_f32_16x16x32_bf16 v[108:111], a[200:203], v[128:131], v[108:111]
    s_add_u32 s42, s26, s96
    v_mfma_f32_16x16x32_bf16 v[108:111], a[204:207], v[152:155], v[108:111]
    s_add_u32 m0, s23, 0x2000
    v_mfma_f32_16x16x32_bf16 v[108:111], a[208:211], v[176:179], v[108:111]
    buffer_load_dwordx4 v1, s[12:15], s42 offen nt lds
    v_mfma_f32_16x16x32_bf16 v[108:111], a[212:215], v[200:203], v[108:111]
    v_mfma_f32_16x16x32_bf16 v[108:111], a[216:219], v[224:227], v[108:111]
    buffer_load_dwordx4 v2, s[12:15], s42 offen offset:1024 nt lds
    v_mfma_f32_16x16x32_bf16 v[108:111], a[220:223], v[248:251], v[108:111]
    s_waitcnt lgkmcnt(12)
    v_mfma_f32_16x16x32_bf16 v[76:79], a[160:163], v[64:67], 0
    s_add_u32 s42, s26, s97
    ds_read_b64_tr_b16 a[192:193], v5 offset:0
    v_mfma_f32_16x16x32_bf16 v[76:79], a[164:167], v[88:91], v[76:79]
    s_waitcnt lgkmcnt(9)
    ds_read_b64_tr_b16 a[194:195], v5 offset:2048
    v_mfma_f32_16x16x32_bf16 v[76:79], a[168:171], v[112:115], v[76:79]
    s_add_u32 m0, s23, 0x4000
    ds_read_b64_tr_b16 a[196:197], v5 offset:4096
    v_mfma_f32_16x16x32_bf16 v[76:79], a[172:175], v[136:139], v[76:79]
    s_waitcnt lgkmcnt(7)
    ds_read_b64_tr_b16 a[198:199], v5 offset:6144
    v_mfma_f32_16x16x32_bf16 v[76:79], a[176:179], v[160:163], v[76:79]
    buffer_load_dwordx4 v1, s[12:15], s42 offen nt lds
    v_mfma_f32_16x16x32_bf16 v[76:79], a[180:183], v[184:187], v[76:79]
    s_waitcnt lgkmcnt(4)
    ds_read_b64_tr_b16 a[200:201], v5 offset:8192
    v_mfma_f32_16x16x32_bf16 v[76:79], a[184:187], v[208:211], v[76:79]
    ds_read_b64_tr_b16 a[202:203], v5 offset:10240
    v_mfma_f32_16x16x32_bf16 v[76:79], a[188:191], v[232:235], v[76:79]
    ds_read_b64_tr_b16 a[204:205], v5 offset:12288
    v_mfma_f32_16x16x32_bf16 v[52:55], a[160:163], v[72:75], 0
    ds_read_b64_tr_b16 a[206:207], v5 offset:14336
    v_mfma_f32_16x16x32_bf16 v[52:55], a[164:167], v[96:99], v[52:55]
    buffer_load_dwordx4 v2, s[12:15], s42 offen offset:1024 nt lds
    v_mfma_f32_16x16x32_bf16 v[52:55], a[168:171], v[120:123], v[52:55]
    s_add_u32 s42, s26, s98
    ds_read_b64_tr_b16 a[208:209], v5 offset:16384
    v_mfma_f32_16x16x32_bf16 v[52:55], a[172:175], v[144:147], v[52:55]
    s_add_u32 m0, s23, 0x6000
    ds_read_b64_tr_b16 a[210:211], v5 offset:18432
    v_mfma_f32_16x16x32_bf16 v[52:55], a[176:179], v[168:171], v[52:55]
    ds_read_b64_tr_b16 a[212:213], v5 offset:20480
    v_mfma_f32_16x16x32_bf16 v[52:55], a[180:183], v[192:195], v[52:55]
    ds_read_b64_tr_b16 a[214:215], v5 offset:22528
    v_mfma_f32_16x16x32_bf16 v[52:55], a[184:187], v[216:219], v[52:55]
    buffer_load_dwordx4 v1, s[12:15], s42 offen nt lds
    v_mfma_f32_16x16x32_bf16 v[52:55], a[188:191], v[240:243], v[52:55]
    ds_read_b64_tr_b16 a[216:217], v5 offset:24576
    v_mfma_f32_16x16x32_bf16 v[36:39], a[160:163], v[80:83], 0
    ds_read_b64_tr_b16 a[218:219], v5 offset:26624
    v_mfma_f32_16x16x32_bf16 v[36:39], a[164:167], v[104:107], v[36:39]
    ds_read_b64_tr_b16 a[220:221], v5 offset:28672
    v_mfma_f32_16x16x32_bf16 v[36:39], a[168:171], v[128:131], v[36:39]
    ds_read_b64_tr_b16 a[222:223], v5 offset:30720
    v_subrev_u32 v5, 0x10000, v5
    v_mfma_f32_16x16x32_bf16 v[36:39], a[172:175], v[152:155], v[36:39]
    buffer_load_dwordx4 v2, s[12:15], s42 offen offset:1024 nt lds
    v_xor_b32 v5, 0x60, v5
    v_mfma_f32_16x16x32_bf16 v[36:39], a[176:179], v[176:179], v[36:39]
    s_add_u32 s42, s27, s43
    v_mfma_f32_16x16x32_bf16 v[36:39], a[180:183], v[200:203], v[36:39]
    s_add_u32 s42, s42, 0x20000
    v_mfma_f32_16x16x32_bf16 v[36:39], a[184:187], v[224:227], v[36:39]
    s_add_u32 m0, s23, 0x8000
    v_mfma_f32_16x16x32_bf16 v[36:39], a[188:191], v[248:251], v[36:39]
    s_waitcnt lgkmcnt(12)
    buffer_load_dwordx4 v1, s[12:15], s42 offen nt lds
    v_mfma_f32_16x16x32_bf16 v[252:255], a[192:195], v[64:67], 0
    s_waitcnt vmcnt(17)
    s_barrier
    ds_read_b64_tr_b16 a[160:161], v5 offset:0
    v_mfma_f32_16x16x32_bf16 v[252:255], a[196:199], v[88:91], v[252:255]
    s_waitcnt lgkmcnt(9)
    ds_read_b64_tr_b16 a[162:163], v5 offset:2048
    v_mfma_f32_16x16x32_bf16 v[252:255], a[200:203], v[112:115], v[252:255]
    ds_read_b64_tr_b16 a[164:165], v5 offset:4096
    v_mfma_f32_16x16x32_bf16 v[252:255], a[204:207], v[136:139], v[252:255]
    s_waitcnt lgkmcnt(7)
    ds_read_b64_tr_b16 a[166:167], v5 offset:6144
    v_mfma_f32_16x16x32_bf16 v[252:255], a[208:211], v[160:163], v[252:255]
    buffer_load_dwordx4 v2, s[12:15], s42 offen offset:1024 nt lds
    v_mfma_f32_16x16x32_bf16 v[252:255], a[212:215], v[184:187], v[252:255]
    s_waitcnt lgkmcnt(4)
    ds_read_b64_tr_b16 a[168:169], v5 offset:8192
    v_mfma_f32_16x16x32_bf16 v[252:255], a[216:219], v[208:211], v[252:255]
    s_add_u32 s42, s27, s96
    ds_read_b64_tr_b16 a[170:171], v5 offset:10240
    v_mfma_f32_16x16x32_bf16 v[252:255], a[220:223], v[232:235], v[252:255]
    s_add_u32 s42, s42, 0x20000
    ds_read_b64_tr_b16 a[172:173], v5 offset:12288
    v_mfma_f32_16x16x32_bf16 v[236:239], a[192:195], v[72:75], 0
    s_add_u32 m0, s23, 0xa000
    ds_read_b64_tr_b16 a[174:175], v5 offset:14336
    v_mfma_f32_16x16x32_bf16 v[236:239], a[196:199], v[96:99], v[236:239]
    buffer_load_dwordx4 v1, s[12:15], s42 offen nt lds
    v_mfma_f32_16x16x32_bf16 v[236:239], a[200:203], v[120:123], v[236:239]
    ds_read_b64_tr_b16 a[176:177], v5 offset:16384
    v_mfma_f32_16x16x32_bf16 v[236:239], a[204:207], v[144:147], v[236:239]
    ds_read_b64_tr_b16 a[178:179], v5 offset:18432
    v_mfma_f32_16x16x32_bf16 v[236:239], a[208:211], v[168:171], v[236:239]
    ds_read_b64_tr_b16 a[180:181], v5 offset:20480
    v_mfma_f32_16x16x32_bf16 v[236:239], a[212:215], v[192:195], v[236:239]
    ds_read_b64_tr_b16 a[182:183], v5 offset:22528
    v_mfma_f32_16x16x32_bf16 v[236:239], a[216:219], v[216:219], v[236:239]
    buffer_load_dwordx4 v2, s[12:15], s42 offen offset:1024 nt lds
    v_mfma_f32_16x16x32_bf16 v[236:239], a[220:223], v[240:243], v[236:239]
    s_add_u32 s42, s27, s97
    ds_read_b64_tr_b16 a[184:185], v5 offset:24576
    v_mfma_f32_16x16x32_bf16 v[220:223], a[192:195], v[80:83], 0
    s_add_u32 s42, s42, 0x20000
    ds_read_b64_tr_b16 a[186:187], v5 offset:26624
    v_mfma_f32_16x16x32_bf16 v[220:223], a[196:199], v[104:107], v[220:223]
    s_add_u32 m0, s23, 0xc000
    ds_read_b64_tr_b16 a[188:189], v5 offset:28672
    v_mfma_f32_16x16x32_bf16 v[220:223], a[200:203], v[128:131], v[220:223]
    ds_read_b64_tr_b16 a[190:191], v5 offset:30720
    v_xor_b32 v5, 32, v5
    v_mfma_f32_16x16x32_bf16 v[220:223], a[204:207], v[152:155], v[220:223]
    buffer_load_dwordx4 v1, s[12:15], s42 offen nt lds
    v_mfma_f32_16x16x32_bf16 v[220:223], a[208:211], v[176:179], v[220:223]
    v_mfma_f32_16x16x32_bf16 v[220:223], a[212:215], v[200:203], v[220:223]
    buffer_load_dwordx4 v2, s[12:15], s42 offen offset:1024 nt lds
    v_mfma_f32_16x16x32_bf16 v[220:223], a[216:219], v[224:227], v[220:223]
    s_add_u32 s42, s27, s98
    v_mfma_f32_16x16x32_bf16 v[220:223], a[220:223], v[248:251], v[220:223]
    s_waitcnt lgkmcnt(12)
    v_mfma_f32_16x16x32_bf16 v[8:11], a[160:163], v[68:71], v[8:11]
    s_barrier
    ds_read_b64_tr_b16 a[192:193], v5 offset:0
    v_add_u32 v3, 0x20000, v3
    v_mfma_f32_16x16x32_bf16 v[8:11], a[164:167], v[116:119], v[8:11]
    s_waitcnt lgkmcnt(9)
    ds_read_b64_tr_b16 a[194:195], v5 offset:2048
    v_add_u32 v4, 0x20000, v4
    v_mfma_f32_16x16x32_bf16 v[8:11], a[168:171], v[164:167], v[8:11]
    s_add_u32 s42, s42, 0x20000
    ds_read_b64_tr_b16 a[196:197], v5 offset:4096
    v_mfma_f32_16x16x32_bf16 v[8:11], a[172:175], v[212:215], v[8:11]
    s_waitcnt lgkmcnt(7)
    ds_read_b64_tr_b16 a[198:199], v5 offset:6144
    v_mfma_f32_16x16x32_bf16 v[8:11], a[176:179], v[28:31], v[8:11]
    buffer_store_dwordx4 a[64:67], v7, s[16:19], s28 offen sc1
    v_mfma_f32_16x16x32_bf16 v[8:11], a[180:183], v[92:95], v[8:11]
    s_waitcnt lgkmcnt(4)
    ds_read_b64_tr_b16 a[200:201], v5 offset:8192
    v_mfma_f32_16x16x32_bf16 v[8:11], a[184:187], v[188:191], v[8:11]
    s_add_u32 m0, s23, 0xe000
    ds_read_b64_tr_b16 a[202:203], v5 offset:10240
    v_mfma_f32_16x16x32_bf16 v[8:11], a[188:191], v[40:43], v[8:11]
    ds_read_b64_tr_b16 a[204:205], v5 offset:12288
    v_mfma_f32_16x16x32_bf16 v[20:23], a[160:163], v[84:87], v[20:23]
    ds_read_b64_tr_b16 a[206:207], v5 offset:14336
    v_mfma_f32_16x16x32_bf16 v[20:23], a[164:167], v[132:135], v[20:23]
    buffer_load_dwordx4 v1, s[12:15], s42 offen nt lds
    v_mfma_f32_16x16x32_bf16 v[20:23], a[168:171], v[180:183], v[20:23]
    ds_read_b64_tr_b16 a[208:209], v5 offset:16384
    v_mfma_f32_16x16x32_bf16 v[20:23], a[172:175], v[228:231], v[20:23]
    ds_read_b64_tr_b16 a[210:211], v5 offset:18432
    v_mfma_f32_16x16x32_bf16 v[20:23], a[176:179], v[44:47], v[20:23]
    ds_read_b64_tr_b16 a[212:213], v5 offset:20480
    v_mfma_f32_16x16x32_bf16 v[20:23], a[180:183], v[124:127], v[20:23]
    ds_read_b64_tr_b16 a[214:215], v5 offset:22528
    v_mul_f32 v8, v8, v12
    v_mfma_f32_16x16x32_bf16 v[20:23], a[184:187], v[24:27], v[20:23]
    buffer_load_dwordx4 v2, s[12:15], s42 offen offset:1024 nt lds
    v_mul_f32 v9, v9, v12
    v_mfma_f32_16x16x32_bf16 v[20:23], a[188:191], v[48:51], v[20:23]
    ds_read_b64_tr_b16 a[216:217], v5 offset:24576
    v_mul_f32 v10, v10, v12
    v_mfma_f32_16x16x32_bf16 v[204:207], a[160:163], v[100:103], v[204:207]
    ds_read_b64_tr_b16 a[218:219], v5 offset:26624
    v_mul_f32 v11, v11, v12
    v_mfma_f32_16x16x32_bf16 v[204:207], a[164:167], v[148:151], v[204:207]
    ds_read_b64_tr_b16 a[220:221], v5 offset:28672
    v_cvt_pk_bf16_f32 v8, v8, v9
    v_mfma_f32_16x16x32_bf16 v[204:207], a[168:171], v[196:199], v[204:207]
    ds_read_b64_tr_b16 a[222:223], v5 offset:30720
    v_xor_b32 v5, 0x60, v5
    v_mfma_f32_16x16x32_bf16 v[204:207], a[172:175], v[244:247], v[204:207]
    buffer_store_dwordx4 a[68:71], v6, s[16:19], s28 offen sc1
    v_cvt_pk_bf16_f32 v9, v10, v11
    v_mfma_f32_16x16x32_bf16 v[204:207], a[176:179], v[60:63], v[204:207]
    ds_write_b64 v3, v[8:9] offset:0
    v_mfma_f32_16x16x32_bf16 v[204:207], a[180:183], v[156:159], v[204:207]
    v_mul_f32 v20, v20, v14
    v_mul_f32 v21, v21, v14
    v_mfma_f32_16x16x32_bf16 v[204:207], a[184:187], v[32:35], v[204:207]
    v_mul_f32 v22, v22, v14
    v_mul_f32 v23, v23, v14
    v_mfma_f32_16x16x32_bf16 v[204:207], a[188:191], v[56:59], v[204:207]
    s_waitcnt lgkmcnt(13)
    v_cvt_pk_bf16_f32 v20, v20, v21
    v_cvt_pk_bf16_f32 v21, v22, v23
    v_mfma_f32_16x16x32_bf16 v[172:175], a[192:195], v[68:71], v[172:175]
    ds_read_b64_tr_b16 a[160:161], v5 offset:0
    v_mfma_f32_16x16x32_bf16 v[172:175], a[196:199], v[116:119], v[172:175]
    s_waitcnt lgkmcnt(10)
    ds_read_b64_tr_b16 a[162:163], v5 offset:2048
    v_mfma_f32_16x16x32_bf16 v[172:175], a[200:203], v[164:167], v[172:175]
    ds_read_b64_tr_b16 a[164:165], v5 offset:4096
    v_mfma_f32_16x16x32_bf16 v[172:175], a[204:207], v[212:215], v[172:175]
    s_waitcnt lgkmcnt(8)
    ds_read_b64_tr_b16 a[166:167], v5 offset:6144
    v_mfma_f32_16x16x32_bf16 v[172:175], a[208:211], v[28:31], v[172:175]
    ds_write_b64 v3, v[20:21] offset:2304
    v_mfma_f32_16x16x32_bf16 v[172:175], a[212:215], v[92:95], v[172:175]
    s_waitcnt lgkmcnt(6)
    ds_read_b64_tr_b16 a[168:169], v5 offset:8192
    v_mul_f32 v204, v204, v16
    v_mfma_f32_16x16x32_bf16 v[172:175], a[216:219], v[188:191], v[172:175]
    ds_read_b64_tr_b16 a[170:171], v5 offset:10240
    v_mul_f32 v205, v205, v16
    v_mfma_f32_16x16x32_bf16 v[172:175], a[220:223], v[40:43], v[172:175]
    ds_read_b64_tr_b16 a[172:173], v5 offset:12288
    v_mul_f32 v206, v206, v16
    v_mfma_f32_16x16x32_bf16 v[140:143], a[192:195], v[84:87], v[140:143]
    ds_read_b64_tr_b16 a[174:175], v5 offset:14336
    v_mul_f32 v207, v207, v16
    v_mfma_f32_16x16x32_bf16 v[140:143], a[196:199], v[132:135], v[140:143]
    buffer_store_dwordx4 a[72:75], v7, s[16:19], s29 offen sc1
    v_cvt_pk_bf16_f32 v204, v204, v205
    v_mfma_f32_16x16x32_bf16 v[140:143], a[200:203], v[180:183], v[140:143]
    ds_read_b64_tr_b16 a[176:177], v5 offset:16384
    v_cvt_pk_bf16_f32 v205, v206, v207
    v_mfma_f32_16x16x32_bf16 v[140:143], a[204:207], v[228:231], v[140:143]
    ds_read_b64_tr_b16 a[178:179], v5 offset:18432
    v_mfma_f32_16x16x32_bf16 v[140:143], a[208:211], v[44:47], v[140:143]
    ds_read_b64_tr_b16 a[180:181], v5 offset:20480
    v_mfma_f32_16x16x32_bf16 v[140:143], a[212:215], v[124:127], v[140:143]
    ds_read_b64_tr_b16 a[182:183], v5 offset:22528
    v_mfma_f32_16x16x32_bf16 v[140:143], a[216:219], v[24:27], v[140:143]
    ds_write_b64 v3, v[204:205] offset:4608
    v_mfma_f32_16x16x32_bf16 v[140:143], a[220:223], v[48:51], v[140:143]
    ds_read_b64_tr_b16 a[184:185], v5 offset:24576
    v_mul_f32 v172, v172, v12
    v_mfma_f32_16x16x32_bf16 v[108:111], a[192:195], v[100:103], v[108:111]
    ds_read_b64_tr_b16 a[186:187], v5 offset:26624
    v_mul_f32 v173, v173, v12
    v_mfma_f32_16x16x32_bf16 v[108:111], a[196:199], v[148:151], v[108:111]
    ds_read_b64_tr_b16 a[188:189], v5 offset:28672
    v_mul_f32 v174, v174, v12
    v_mfma_f32_16x16x32_bf16 v[108:111], a[200:203], v[196:199], v[108:111]
    ds_read_b64_tr_b16 a[190:191], v5 offset:30720
    v_xor_b32 v5, 32, v5
    v_mfma_f32_16x16x32_bf16 v[108:111], a[204:207], v[244:247], v[108:111]
    v_mul_f32 v175, v175, v12
    v_cvt_pk_bf16_f32 v172, v172, v173
    v_mfma_f32_16x16x32_bf16 v[108:111], a[208:211], v[60:63], v[108:111]
    v_cvt_pk_bf16_f32 v173, v174, v175
    v_mfma_f32_16x16x32_bf16 v[108:111], a[212:215], v[156:159], v[108:111]
    ds_write_b64 v3, v[172:173] offset:32
    v_mfma_f32_16x16x32_bf16 v[108:111], a[216:219], v[32:35], v[108:111]
    buffer_store_dwordx4 a[76:79], v6, s[16:19], s29 offen sc1
    v_mul_f32 v140, v140, v14
    v_mfma_f32_16x16x32_bf16 v[108:111], a[220:223], v[56:59], v[108:111]
    s_waitcnt lgkmcnt(15)
    v_mul_f32 v141, v141, v14
    v_mul_f32 v142, v142, v14
    v_mfma_f32_16x16x32_bf16 v[76:79], a[160:163], v[68:71], v[76:79]
    ds_read_b64_tr_b16 a[192:193], v5 offset:0
    v_mul_f32 v143, v143, v14
    v_mfma_f32_16x16x32_bf16 v[76:79], a[164:167], v[116:119], v[76:79]
    s_waitcnt lgkmcnt(11)
    ds_read_b64_tr_b16 a[194:195], v5 offset:2048
    v_cvt_pk_bf16_f32 v140, v140, v141
    v_mfma_f32_16x16x32_bf16 v[76:79], a[168:171], v[164:167], v[76:79]
    ds_read_b64_tr_b16 a[196:197], v5 offset:4096
    v_cvt_pk_bf16_f32 v141, v142, v143
    v_mfma_f32_16x16x32_bf16 v[76:79], a[172:175], v[212:215], v[76:79]
    s_waitcnt lgkmcnt(9)
    ds_read_b64_tr_b16 a[198:199], v5 offset:6144
    v_mfma_f32_16x16x32_bf16 v[76:79], a[176:179], v[28:31], v[76:79]
    ds_write_b64 v3, v[140:141] offset:2336
    v_mfma_f32_16x16x32_bf16 v[76:79], a[180:183], v[92:95], v[76:79]
    s_waitcnt lgkmcnt(6)
    ds_read_b64_tr_b16 a[200:201], v5 offset:8192
    v_mul_f32 v108, v108, v16
    v_mfma_f32_16x16x32_bf16 v[76:79], a[184:187], v[188:191], v[76:79]
    ds_read_b64_tr_b16 a[202:203], v5 offset:10240
    v_mul_f32 v109, v109, v16
    v_mfma_f32_16x16x32_bf16 v[76:79], a[188:191], v[40:43], v[76:79]
    ds_read_b64_tr_b16 a[204:205], v5 offset:12288
    v_mul_f32 v110, v110, v16
    v_mfma_f32_16x16x32_bf16 v[52:55], a[160:163], v[84:87], v[52:55]
    ds_read_b64_tr_b16 a[206:207], v5 offset:14336
    v_mul_f32 v111, v111, v16
    v_mfma_f32_16x16x32_bf16 v[52:55], a[164:167], v[132:135], v[52:55]
    ds_read_b64_tr_b16 a[208:209], v5 offset:16384
    v_cvt_pk_bf16_f32 v108, v108, v109
    v_mfma_f32_16x16x32_bf16 v[52:55], a[168:171], v[180:183], v[52:55]
    ds_read_b64_tr_b16 a[210:211], v5 offset:18432
    v_cvt_pk_bf16_f32 v109, v110, v111
    v_mfma_f32_16x16x32_bf16 v[52:55], a[172:175], v[228:231], v[52:55]
    ds_read_b64_tr_b16 a[212:213], v5 offset:20480
    v_mfma_f32_16x16x32_bf16 v[52:55], a[176:179], v[44:47], v[52:55]
    ds_read_b64_tr_b16 a[214:215], v5 offset:22528
    v_mfma_f32_16x16x32_bf16 v[52:55], a[180:183], v[124:127], v[52:55]
    ds_read_b64_tr_b16 a[216:217], v5 offset:24576
    v_mfma_f32_16x16x32_bf16 v[52:55], a[184:187], v[24:27], v[52:55]
    ds_write_b64 v3, v[108:109] offset:4640
    v_mfma_f32_16x16x32_bf16 v[52:55], a[188:191], v[48:51], v[52:55]
    ds_read_b64_tr_b16 a[218:219], v5 offset:26624
    v_mul_f32 v76, v76, v12
    v_mfma_f32_16x16x32_bf16 v[36:39], a[160:163], v[100:103], v[36:39]
    ds_read_b64_tr_b16 a[220:221], v5 offset:28672
    v_mul_f32 v77, v77, v12
    v_mfma_f32_16x16x32_bf16 v[36:39], a[164:167], v[148:151], v[36:39]
    ds_read_b64_tr_b16 a[222:223], v5 offset:30720
    v_xor_b32 v5, 0x60, v5
    v_mfma_f32_16x16x32_bf16 v[36:39], a[168:171], v[196:199], v[36:39]
    buffer_store_dwordx4 a[80:83], v7, s[16:19], s30 offen sc1
    v_mul_f32 v78, v78, v12
    v_mfma_f32_16x16x32_bf16 v[36:39], a[172:175], v[244:247], v[36:39]
    v_mul_f32 v79, v79, v12
    v_cvt_pk_bf16_f32 v76, v76, v77
    v_mfma_f32_16x16x32_bf16 v[36:39], a[176:179], v[60:63], v[36:39]
    v_cvt_pk_bf16_f32 v77, v78, v79
    v_mfma_f32_16x16x32_bf16 v[36:39], a[180:183], v[156:159], v[36:39]
    ds_write_b64 v3, v[76:77] offset:64
    v_mfma_f32_16x16x32_bf16 v[36:39], a[184:187], v[32:35], v[36:39]
    v_mul_f32 v52, v52, v14
    v_mul_f32 v53, v53, v14
    v_mfma_f32_16x16x32_bf16 v[36:39], a[188:191], v[56:59], v[36:39]
    s_waitcnt lgkmcnt(15)
    v_mul_f32 v54, v54, v14
    v_mul_f32 v55, v55, v14
    v_mfma_f32_16x16x32_bf16 v[252:255], a[192:195], v[68:71], v[252:255]
    s_waitcnt vmcnt(21)
    s_barrier
    ds_read_b64_tr_b16 a[160:161], v5 offset:32768
    v_mfma_f32_16x16x32_bf16 v[252:255], a[196:199], v[116:119], v[252:255]
    s_waitcnt lgkmcnt(11)
    ds_read_b64_tr_b16 a[162:163], v5 offset:34816
    v_cvt_pk_bf16_f32 v52, v52, v53
    v_mfma_f32_16x16x32_bf16 v[252:255], a[200:203], v[164:167], v[252:255]
    ds_read_b64_tr_b16 a[164:165], v5 offset:36864
    v_cvt_pk_bf16_f32 v53, v54, v55
    v_mfma_f32_16x16x32_bf16 v[252:255], a[204:207], v[212:215], v[252:255]
    s_waitcnt lgkmcnt(9)
    ds_read_b64_tr_b16 a[166:167], v5 offset:38912
    v_mfma_f32_16x16x32_bf16 v[252:255], a[208:211], v[28:31], v[252:255]
    ds_write_b64 v3, v[52:53] offset:2368
    v_mfma_f32_16x16x32_bf16 v[252:255], a[212:215], v[92:95], v[252:255]
    s_waitcnt lgkmcnt(6)
    ds_read_b64_tr_b16 a[168:169], v5 offset:40960
    v_mul_f32 v36, v36, v16
    v_mfma_f32_16x16x32_bf16 v[252:255], a[216:219], v[188:191], v[252:255]
    ds_read_b64_tr_b16 a[170:171], v5 offset:43008
    v_mul_f32 v37, v37, v16
    v_mfma_f32_16x16x32_bf16 v[252:255], a[220:223], v[40:43], v[252:255]
    ds_read_b64_tr_b16 a[172:173], v5 offset:45056
    v_mul_f32 v38, v38, v16
    v_mfma_f32_16x16x32_bf16 v[236:239], a[192:195], v[84:87], v[236:239]
    ds_read_b64_tr_b16 a[174:175], v5 offset:47104
    v_mul_f32 v39, v39, v16
    v_mfma_f32_16x16x32_bf16 v[236:239], a[196:199], v[132:135], v[236:239]
    ds_read_b64_tr_b16 a[176:177], v5 offset:49152
    v_cvt_pk_bf16_f32 v36, v36, v37
    v_mfma_f32_16x16x32_bf16 v[236:239], a[200:203], v[180:183], v[236:239]
    ds_read_b64_tr_b16 a[178:179], v5 offset:51200
    v_cvt_pk_bf16_f32 v37, v38, v39
    v_mfma_f32_16x16x32_bf16 v[236:239], a[204:207], v[228:231], v[236:239]
    ds_read_b64_tr_b16 a[180:181], v5 offset:53248
    v_mfma_f32_16x16x32_bf16 v[236:239], a[208:211], v[44:47], v[236:239]
    ds_read_b64_tr_b16 a[182:183], v5 offset:55296
    v_mfma_f32_16x16x32_bf16 v[236:239], a[212:215], v[124:127], v[236:239]
    ds_read_b64_tr_b16 a[184:185], v5 offset:57344
    v_mfma_f32_16x16x32_bf16 v[236:239], a[216:219], v[24:27], v[236:239]
    ds_write_b64 v3, v[36:37] offset:4672
    v_mfma_f32_16x16x32_bf16 v[236:239], a[220:223], v[48:51], v[236:239]
    ds_read_b64_tr_b16 a[186:187], v5 offset:59392
    v_mul_f32 v252, v252, v12
    v_mfma_f32_16x16x32_bf16 v[220:223], a[192:195], v[100:103], v[220:223]
    ds_read_b64_tr_b16 a[188:189], v5 offset:61440
    v_mul_f32 v253, v253, v12
    v_mfma_f32_16x16x32_bf16 v[220:223], a[196:199], v[148:151], v[220:223]
    ds_read_b64_tr_b16 a[190:191], v5 offset:63488
    v_xor_b32 v5, 32, v5
    v_mfma_f32_16x16x32_bf16 v[220:223], a[200:203], v[196:199], v[220:223]
    v_mul_f32 v254, v254, v12
    v_mul_f32 v255, v255, v12
    v_mfma_f32_16x16x32_bf16 v[220:223], a[204:207], v[244:247], v[220:223]
    v_cvt_pk_bf16_f32 v252, v252, v253
    v_cvt_pk_bf16_f32 v253, v254, v255
    v_mfma_f32_16x16x32_bf16 v[220:223], a[208:211], v[60:63], v[220:223]
    ds_write_b64 v3, v[252:253] offset:96
    v_mfma_f32_16x16x32_bf16 v[220:223], a[212:215], v[156:159], v[220:223]
    ds_read_b128 a[88:91], v4 offset:0
    v_mfma_f32_16x16x32_bf16 v[220:223], a[216:219], v[32:35], v[220:223]
    ds_read_b128 a[92:95], v4 offset:1152
    v_mul_f32 v236, v236, v14
    v_mfma_f32_16x16x32_bf16 v[220:223], a[220:223], v[56:59], v[220:223]
    s_waitcnt lgkmcnt(15)
    v_mul_f32 v237, v237, v14
    v_mul_f32 v238, v238, v14
    v_mfma_f32_16x16x32_bf16 v[8:11], a[160:163], v[64:67], 0
    ds_read_b64_tr_b16 a[192:193], v5 offset:32768
    v_mul_f32 v239, v239, v14
    v_mfma_f32_16x16x32_bf16 v[8:11], a[164:167], v[88:91], v[8:11]
    s_waitcnt lgkmcnt(13)
    ds_read_b64_tr_b16 a[194:195], v5 offset:34816
    v_cvt_pk_bf16_f32 v236, v236, v237
    v_mfma_f32_16x16x32_bf16 v[8:11], a[168:171], v[112:115], v[8:11]
    ds_read_b64_tr_b16 a[196:197], v5 offset:36864
    v_cvt_pk_bf16_f32 v237, v238, v239
    v_mfma_f32_16x16x32_bf16 v[8:11], a[172:175], v[136:139], v[8:11]
    s_waitcnt lgkmcnt(11)
    ds_read_b64_tr_b16 a[198:199], v5 offset:38912
    v_mfma_f32_16x16x32_bf16 v[8:11], a[176:179], v[160:163], v[8:11]
    ds_write_b64 v3, v[236:237] offset:2400
    v_mfma_f32_16x16x32_bf16 v[8:11], a[180:183], v[184:187], v[8:11]
    s_waitcnt lgkmcnt(8)
    ds_read_b64_tr_b16 a[200:201], v5 offset:40960
    v_mfma_f32_16x16x32_bf16 v[8:11], a[184:187], v[208:211], v[8:11]
    ds_read_b64_tr_b16 a[202:203], v5 offset:43008
    v_mfma_f32_16x16x32_bf16 v[8:11], a[188:191], v[232:235], v[8:11]
    ds_read_b64_tr_b16 a[204:205], v5 offset:45056
    v_mfma_f32_16x16x32_bf16 v[20:23], a[160:163], v[72:75], 0
    ds_read_b64_tr_b16 a[206:207], v5 offset:47104
    v_mfma_f32_16x16x32_bf16 v[20:23], a[164:167], v[96:99], v[20:23]
    ds_read_b128 a[96:99], v4 offset:2304
    v_mfma_f32_16x16x32_bf16 v[20:23], a[168:171], v[120:123], v[20:23]
    ds_read_b64_tr_b16 a[208:209], v5 offset:49152
    v_mfma_f32_16x16x32_bf16 v[20:23], a[172:175], v[144:147], v[20:23]
    ds_read_b64_tr_b16 a[210:211], v5 offset:51200
    v_mfma_f32_16x16x32_bf16 v[20:23], a[176:179], v[168:171], v[20:23]
    ds_read_b64_tr_b16 a[212:213], v5 offset:53248
    v_mfma_f32_16x16x32_bf16 v[20:23], a[180:183], v[192:195], v[20:23]
    ds_read_b64_tr_b16 a[214:215], v5 offset:55296
    v_mfma_f32_16x16x32_bf16 v[20:23], a[184:187], v[216:219], v[20:23]
    ds_read_b128 a[100:103], v4 offset:3456
    v_mul_f32 v220, v220, v16
    v_mfma_f32_16x16x32_bf16 v[20:23], a[188:191], v[240:243], v[20:23]
    ds_read_b64_tr_b16 a[216:217], v5 offset:57344
    v_mul_f32 v221, v221, v16
    v_mfma_f32_16x16x32_bf16 v[204:207], a[160:163], v[80:83], 0
    ds_read_b64_tr_b16 a[218:219], v5 offset:59392
    v_mul_f32 v222, v222, v16
    v_mfma_f32_16x16x32_bf16 v[204:207], a[164:167], v[104:107], v[204:207]
    ds_read_b64_tr_b16 a[220:221], v5 offset:61440
    v_mul_f32 v223, v223, v16
    v_mfma_f32_16x16x32_bf16 v[204:207], a[168:171], v[128:131], v[204:207]
    ds_read_b64_tr_b16 a[222:223], v5 offset:63488
    v_xor_b32 v5, 0x60, v5
    v_mfma_f32_16x16x32_bf16 v[204:207], a[172:175], v[152:155], v[204:207]
    v_cvt_pk_bf16_f32 v220, v220, v221
    v_cvt_pk_bf16_f32 v221, v222, v223
    v_mfma_f32_16x16x32_bf16 v[204:207], a[176:179], v[176:179], v[204:207]
    ds_write_b64 v3, v[220:221] offset:4704
    v_mfma_f32_16x16x32_bf16 v[204:207], a[180:183], v[200:203], v[204:207]
    ds_read_b128 a[104:107], v4 offset:4608
    v_mfma_f32_16x16x32_bf16 v[204:207], a[184:187], v[224:227], v[204:207]
    ds_read_b128 a[108:111], v4 offset:5760
    v_mfma_f32_16x16x32_bf16 v[204:207], a[188:191], v[248:251], v[204:207]
    s_waitcnt lgkmcnt(15)
    v_mfma_f32_16x16x32_bf16 v[172:175], a[192:195], v[64:67], 0
    ds_read_b64_tr_b16 a[160:161], v5 offset:32768
    v_mfma_f32_16x16x32_bf16 v[172:175], a[196:199], v[88:91], v[172:175]
    s_waitcnt lgkmcnt(14)
    ds_read_b64_tr_b16 a[162:163], v5 offset:34816
    v_mfma_f32_16x16x32_bf16 v[172:175], a[200:203], v[112:115], v[172:175]
    ds_read_b64_tr_b16 a[164:165], v5 offset:36864
    v_mfma_f32_16x16x32_bf16 v[172:175], a[204:207], v[136:139], v[172:175]
    s_waitcnt lgkmcnt(11)
    ds_read_b64_tr_b16 a[166:167], v5 offset:38912
    v_mfma_f32_16x16x32_bf16 v[172:175], a[208:211], v[160:163], v[172:175]
    ds_read_b64_tr_b16 a[168:169], v5 offset:40960
    v_mfma_f32_16x16x32_bf16 v[172:175], a[212:215], v[184:187], v[172:175]
    s_waitcnt lgkmcnt(8)
    ds_read_b64_tr_b16 a[170:171], v5 offset:43008
    v_mfma_f32_16x16x32_bf16 v[172:175], a[216:219], v[208:211], v[172:175]
    ds_read_b64_tr_b16 a[172:173], v5 offset:45056
L_pg7:
    s_cbranch_execz L_warm_done
    v_mfma_f32_16x16x32_bf16 v[172:175], a[220:223], v[232:235], v[172:175]
    ds_read_b64_tr_b16 a[174:175], v5 offset:47104
    v_mfma_f32_16x16x32_bf16 v[140:143], a[192:195], v[72:75], 0
    s_waitcnt lgkmcnt(8)
    s_barrier
    ds_read_b64_tr_b16 a[176:177], v5 offset:49152
    v_mfma_f32_16x16x32_bf16 v[140:143], a[196:199], v[96:99], v[140:143]
    s_add_u32 s42, s27, s43
    ds_read_b64_tr_b16 a[178:179], v5 offset:51200
    v_mfma_f32_16x16x32_bf16 v[140:143], a[200:203], v[120:123], v[140:143]
    s_add_u32 m0, s23, 0x10000
    ds_read_b64_tr_b16 a[180:181], v5 offset:53248
    v_mfma_f32_16x16x32_bf16 v[140:143], a[204:207], v[144:147], v[140:143]
    ds_read_b64_tr_b16 a[182:183], v5 offset:55296
    v_mfma_f32_16x16x32_bf16 v[140:143], a[208:211], v[168:171], v[140:143]
    ds_read_b64_tr_b16 a[184:185], v5 offset:57344
    v_mfma_f32_16x16x32_bf16 v[140:143], a[212:215], v[192:195], v[140:143]
    ds_read_b64_tr_b16 a[186:187], v5 offset:59392
    v_mfma_f32_16x16x32_bf16 v[140:143], a[216:219], v[216:219], v[140:143]
    buffer_load_dwordx4 v1, s[12:15], s42 offen nt lds
    v_mfma_f32_16x16x32_bf16 v[140:143], a[220:223], v[240:243], v[140:143]
    ds_read_b64_tr_b16 a[188:189], v5 offset:61440
    v_mfma_f32_16x16x32_bf16 v[108:111], a[192:195], v[80:83], 0
    ds_read_b64_tr_b16 a[190:191], v5 offset:63488
    v_xor_b32 v5, 32, v5
    v_mfma_f32_16x16x32_bf16 v[108:111], a[196:199], v[104:107], v[108:111]
    buffer_load_dwordx4 v2, s[12:15], s42 offen offset:1024 nt lds
    v_mfma_f32_16x16x32_bf16 v[108:111], a[200:203], v[128:131], v[108:111]
    s_add_u32 s42, s27, s96
    v_mfma_f32_16x16x32_bf16 v[108:111], a[204:207], v[152:155], v[108:111]
    s_add_u32 m0, s23, 0x12000
    v_mfma_f32_16x16x32_bf16 v[108:111], a[208:211], v[176:179], v[108:111]
    buffer_load_dwordx4 v1, s[12:15], s42 offen nt lds
    v_mfma_f32_16x16x32_bf16 v[108:111], a[212:215], v[200:203], v[108:111]
    v_mfma_f32_16x16x32_bf16 v[108:111], a[216:219], v[224:227], v[108:111]
    buffer_load_dwordx4 v2, s[12:15], s42 offen offset:1024 nt lds
    v_mfma_f32_16x16x32_bf16 v[108:111], a[220:223], v[248:251], v[108:111]
    s_waitcnt lgkmcnt(12)
    v_mfma_f32_16x16x32_bf16 v[76:79], a[160:163], v[64:67], 0
    s_add_u32 s42, s27, s97
    ds_read_b64_tr_b16 a[192:193], v5 offset:32768
    v_mfma_f32_16x16x32_bf16 v[76:79], a[164:167], v[88:91], v[76:79]
    s_waitcnt lgkmcnt(9)
    ds_read_b64_tr_b16 a[194:195], v5 offset:34816
    v_mfma_f32_16x16x32_bf16 v[76:79], a[168:171], v[112:115], v[76:79]
    s_add_u32 m0, s23, 0x14000
    ds_read_b64_tr_b16 a[196:197], v5 offset:36864
    v_mfma_f32_16x16x32_bf16 v[76:79], a[172:175], v[136:139], v[76:79]
    s_waitcnt lgkmcnt(7)
    ds_read_b64_tr_b16 a[198:199], v5 offset:38912
    v_mfma_f32_16x16x32_bf16 v[76:79], a[176:179], v[160:163], v[76:79]
    buffer_load_dwordx4 v1, s[12:15], s42 offen nt lds
    v_mfma_f32_16x16x32_bf16 v[76:79], a[180:183], v[184:187], v[76:79]
    s_waitcnt lgkmcnt(4)
    ds_read_b64_tr_b16 a[200:201], v5 offset:40960
    v_mfma_f32_16x16x32_bf16 v[76:79], a[184:187], v[208:211], v[76:79]
    ds_read_b64_tr_b16 a[202:203], v5 offset:43008
    v_mfma_f32_16x16x32_bf16 v[76:79], a[188:191], v[232:235], v[76:79]
    ds_read_b64_tr_b16 a[204:205], v5 offset:45056
    v_mfma_f32_16x16x32_bf16 v[52:55], a[160:163], v[72:75], 0
    ds_read_b64_tr_b16 a[206:207], v5 offset:47104
    v_mfma_f32_16x16x32_bf16 v[52:55], a[164:167], v[96:99], v[52:55]
    buffer_load_dwordx4 v2, s[12:15], s42 offen offset:1024 nt lds
    v_mfma_f32_16x16x32_bf16 v[52:55], a[168:171], v[120:123], v[52:55]
    s_add_u32 s42, s27, s98
    ds_read_b64_tr_b16 a[208:209], v5 offset:49152
    v_mfma_f32_16x16x32_bf16 v[52:55], a[172:175], v[144:147], v[52:55]
    s_add_u32 m0, s23, 0x16000
    ds_read_b64_tr_b16 a[210:211], v5 offset:51200
    v_mfma_f32_16x16x32_bf16 v[52:55], a[176:179], v[168:171], v[52:55]
    ds_read_b64_tr_b16 a[212:213], v5 offset:53248
    v_mfma_f32_16x16x32_bf16 v[52:55], a[180:183], v[192:195], v[52:55]
    ds_read_b64_tr_b16 a[214:215], v5 offset:55296
    v_mfma_f32_16x16x32_bf16 v[52:55], a[184:187], v[216:219], v[52:55]
    buffer_load_dwordx4 v1, s[12:15], s42 offen nt lds
    v_mfma_f32_16x16x32_bf16 v[52:55], a[188:191], v[240:243], v[52:55]
    ds_read_b64_tr_b16 a[216:217], v5 offset:57344
    v_mfma_f32_16x16x32_bf16 v[36:39], a[160:163], v[80:83], 0
    ds_read_b64_tr_b16 a[218:219], v5 offset:59392
    v_mfma_f32_16x16x32_bf16 v[36:39], a[164:167], v[104:107], v[36:39]
    ds_read_b64_tr_b16 a[220:221], v5 offset:61440
    v_mfma_f32_16x16x32_bf16 v[36:39], a[168:171], v[128:131], v[36:39]
    ds_read_b64_tr_b16 a[222:223], v5 offset:63488
    v_subrev_u32 v5, 0x10000, v5
    v_mfma_f32_16x16x32_bf16 v[36:39], a[172:175], v[152:155], v[36:39]
    buffer_load_dwordx4 v2, s[12:15], s42 offen offset:1024 nt lds
    v_xor_b32 v5, 0x60, v5
    v_mfma_f32_16x16x32_bf16 v[36:39], a[176:179], v[176:179], v[36:39]
    buffer_store_dwordx4 a[84:87], v6, s[16:19], s30 offen sc1
    v_mfma_f32_16x16x32_bf16 v[36:39], a[180:183], v[200:203], v[36:39]
    v_mfma_f32_16x16x32_bf16 v[36:39], a[184:187], v[224:227], v[36:39]
    v_mfma_f32_16x16x32_bf16 v[36:39], a[188:191], v[248:251], v[36:39]
    s_waitcnt lgkmcnt(12)
    v_mfma_f32_16x16x32_bf16 v[252:255], a[192:195], v[64:67], 0
    s_waitcnt vmcnt(22)
    s_barrier
    ds_read_b64_tr_b16 a[160:161], v5 offset:0
    v_mfma_f32_16x16x32_bf16 v[252:255], a[196:199], v[88:91], v[252:255]
    s_waitcnt lgkmcnt(9)
    ds_read_b64_tr_b16 a[162:163], v5 offset:2048
    v_mfma_f32_16x16x32_bf16 v[252:255], a[200:203], v[112:115], v[252:255]
    ds_read_b64_tr_b16 a[164:165], v5 offset:4096
    v_mfma_f32_16x16x32_bf16 v[252:255], a[204:207], v[136:139], v[252:255]
    s_waitcnt lgkmcnt(7)
    ds_read_b64_tr_b16 a[166:167], v5 offset:6144
    v_mfma_f32_16x16x32_bf16 v[252:255], a[208:211], v[160:163], v[252:255]
    ds_read_b64_tr_b16 a[168:169], v5 offset:8192
    v_mfma_f32_16x16x32_bf16 v[252:255], a[212:215], v[184:187], v[252:255]
    s_waitcnt lgkmcnt(5)
    ds_read_b64_tr_b16 a[170:171], v5 offset:10240
    v_mfma_f32_16x16x32_bf16 v[252:255], a[216:219], v[208:211], v[252:255]
    ds_read_b64_tr_b16 a[172:173], v5 offset:12288
    v_mfma_f32_16x16x32_bf16 v[252:255], a[220:223], v[232:235], v[252:255]
    ds_read_b64_tr_b16 a[174:175], v5 offset:14336
    v_mfma_f32_16x16x32_bf16 v[236:239], a[192:195], v[72:75], 0
    ds_read_b64_tr_b16 a[176:177], v5 offset:16384
    v_mfma_f32_16x16x32_bf16 v[236:239], a[196:199], v[96:99], v[236:239]
    buffer_store_dwordx4 a[88:91], v7, s[16:19], s31 offen sc1
    v_mfma_f32_16x16x32_bf16 v[236:239], a[200:203], v[120:123], v[236:239]
    ds_read_b64_tr_b16 a[178:179], v5 offset:18432
    v_mfma_f32_16x16x32_bf16 v[236:239], a[204:207], v[144:147], v[236:239]
    ds_read_b64_tr_b16 a[180:181], v5 offset:20480
    v_mfma_f32_16x16x32_bf16 v[236:239], a[208:211], v[168:171], v[236:239]
    ds_read_b64_tr_b16 a[182:183], v5 offset:22528
    v_mfma_f32_16x16x32_bf16 v[236:239], a[212:215], v[192:195], v[236:239]
    ds_read_b64_tr_b16 a[184:185], v5 offset:24576
    v_mfma_f32_16x16x32_bf16 v[236:239], a[216:219], v[216:219], v[236:239]
    ds_read_b64_tr_b16 a[186:187], v5 offset:26624
    v_mfma_f32_16x16x32_bf16 v[236:239], a[220:223], v[240:243], v[236:239]
    ds_read_b64_tr_b16 a[188:189], v5 offset:28672
    v_mfma_f32_16x16x32_bf16 v[220:223], a[192:195], v[80:83], 0
    ds_read_b64_tr_b16 a[190:191], v5 offset:30720
    v_xor_b32 v5, 32, v5
    v_mfma_f32_16x16x32_bf16 v[220:223], a[196:199], v[104:107], v[220:223]
    v_mfma_f32_16x16x32_bf16 v[220:223], a[200:203], v[128:131], v[220:223]
    v_mfma_f32_16x16x32_bf16 v[220:223], a[204:207], v[152:155], v[220:223]
    v_mfma_f32_16x16x32_bf16 v[220:223], a[208:211], v[176:179], v[220:223]
    v_mfma_f32_16x16x32_bf16 v[220:223], a[212:215], v[200:203], v[220:223]
    buffer_store_dwordx4 a[92:95], v6, s[16:19], s31 offen sc1
    v_mfma_f32_16x16x32_bf16 v[220:223], a[216:219], v[224:227], v[220:223]
    v_mfma_f32_16x16x32_bf16 v[220:223], a[220:223], v[248:251], v[220:223]
    s_waitcnt lgkmcnt(12)
    v_mfma_f32_16x16x32_bf16 v[8:11], a[160:163], v[68:71], v[8:11]
    ds_read_b64_tr_b16 a[192:193], v5 offset:0
    v_mfma_f32_16x16x32_bf16 v[8:11], a[164:167], v[116:119], v[8:11]
    s_waitcnt lgkmcnt(9)
    ds_read_b64_tr_b16 a[194:195], v5 offset:2048
    v_mfma_f32_16x16x32_bf16 v[8:11], a[168:171], v[164:167], v[8:11]
    ds_read_b64_tr_b16 a[196:197], v5 offset:4096
    v_mfma_f32_16x16x32_bf16 v[8:11], a[172:175], v[212:215], v[8:11]
    s_waitcnt lgkmcnt(7)
    ds_read_b64_tr_b16 a[198:199], v5 offset:6144
    v_mfma_f32_16x16x32_bf16 v[8:11], a[176:179], v[28:31], v[8:11]
    ds_read_b64_tr_b16 a[200:201], v5 offset:8192
    v_mfma_f32_16x16x32_bf16 v[8:11], a[180:183], v[92:95], v[8:11]
    s_waitcnt lgkmcnt(5)
    ds_read_b64_tr_b16 a[202:203], v5 offset:10240
    v_mfma_f32_16x16x32_bf16 v[8:11], a[184:187], v[188:191], v[8:11]
    ds_read_b64_tr_b16 a[204:205], v5 offset:12288
    v_mfma_f32_16x16x32_bf16 v[8:11], a[188:191], v[40:43], v[8:11]
    ds_read_b64_tr_b16 a[206:207], v5 offset:14336
    v_mfma_f32_16x16x32_bf16 v[20:23], a[160:163], v[84:87], v[20:23]
    ds_read_b64_tr_b16 a[208:209], v5 offset:16384
    v_mfma_f32_16x16x32_bf16 v[20:23], a[164:167], v[132:135], v[20:23]
    buffer_store_dwordx4 a[96:99], v7, s[16:19], s32 offen sc1
    v_mfma_f32_16x16x32_bf16 v[20:23], a[168:171], v[180:183], v[20:23]
    ds_read_b64_tr_b16 a[210:211], v5 offset:18432
    v_mfma_f32_16x16x32_bf16 v[20:23], a[172:175], v[228:231], v[20:23]
    ds_read_b64_tr_b16 a[212:213], v5 offset:20480
    v_mfma_f32_16x16x32_bf16 v[20:23], a[176:179], v[44:47], v[20:23]
    ds_read_b64_tr_b16 a[214:215], v5 offset:22528
    v_mfma_f32_16x16x32_bf16 v[20:23], a[180:183], v[124:127], v[20:23]
    ds_read_b64_tr_b16 a[216:217], v5 offset:24576
    v_mul_f32 v8, v8, v12
    v_mfma_f32_16x16x32_bf16 v[20:23], a[184:187], v[24:27], v[20:23]
    ds_read_b64_tr_b16 a[218:219], v5 offset:26624
    v_mul_f32 v9, v9, v12
    v_mfma_f32_16x16x32_bf16 v[20:23], a[188:191], v[48:51], v[20:23]
    ds_read_b64_tr_b16 a[220:221], v5 offset:28672
    v_mul_f32 v10, v10, v12
    v_mfma_f32_16x16x32_bf16 v[204:207], a[160:163], v[100:103], v[204:207]
    ds_read_b64_tr_b16 a[222:223], v5 offset:30720
    v_xor_b32 v5, 0x60, v5
    v_mfma_f32_16x16x32_bf16 v[204:207], a[164:167], v[148:151], v[204:207]
    v_mul_f32 v11, v11, v12
    v_cvt_pk_bf16_f32 v8, v8, v9
    v_mfma_f32_16x16x32_bf16 v[204:207], a[168:171], v[196:199], v[204:207]
    v_cvt_pk_bf16_f32 v9, v10, v11
    v_mfma_f32_16x16x32_bf16 v[204:207], a[172:175], v[244:247], v[204:207]
    ds_write_b64 v3, v[8:9] offset:0
    v_mfma_f32_16x16x32_bf16 v[204:207], a[176:179], v[60:63], v[204:207]
    v_mfma_f32_16x16x32_bf16 v[204:207], a[180:183], v[156:159], v[204:207]
    buffer_store_dwordx4 a[100:103], v6, s[16:19], s32 offen sc1
    v_mul_f32 v20, v20, v14
    v_mfma_f32_16x16x32_bf16 v[204:207], a[184:187], v[32:35], v[204:207]
    v_mul_f32 v21, v21, v14
    v_mul_f32 v22, v22, v14
    v_mfma_f32_16x16x32_bf16 v[204:207], a[188:191], v[56:59], v[204:207]
    s_waitcnt lgkmcnt(13)
    v_mul_f32 v23, v23, v14
    v_cvt_pk_bf16_f32 v20, v20, v21
    v_mfma_f32_16x16x32_bf16 v[172:175], a[192:195], v[68:71], v[172:175]
    ds_read_b64_tr_b16 a[160:161], v5 offset:0
    v_cvt_pk_bf16_f32 v21, v22, v23
    v_mfma_f32_16x16x32_bf16 v[172:175], a[196:199], v[116:119], v[172:175]
    s_waitcnt lgkmcnt(10)
    ds_read_b64_tr_b16 a[162:163], v5 offset:2048
    v_mfma_f32_16x16x32_bf16 v[172:175], a[200:203], v[164:167], v[172:175]
    ds_read_b64_tr_b16 a[164:165], v5 offset:4096
    v_mfma_f32_16x16x32_bf16 v[172:175], a[204:207], v[212:215], v[172:175]
    s_waitcnt lgkmcnt(8)
    ds_read_b64_tr_b16 a[166:167], v5 offset:6144
    v_mfma_f32_16x16x32_bf16 v[172:175], a[208:211], v[28:31], v[172:175]
    ds_write_b64 v3, v[20:21] offset:2304
    v_mfma_f32_16x16x32_bf16 v[172:175], a[212:215], v[92:95], v[172:175]
    s_waitcnt lgkmcnt(6)
    ds_read_b64_tr_b16 a[168:169], v5 offset:8192
    v_mul_f32 v204, v204, v16
    v_mfma_f32_16x16x32_bf16 v[172:175], a[216:219], v[188:191], v[172:175]
    ds_read_b64_tr_b16 a[170:171], v5 offset:10240
    v_mul_f32 v205, v205, v16
    v_mfma_f32_16x16x32_bf16 v[172:175], a[220:223], v[40:43], v[172:175]
    ds_read_b64_tr_b16 a[172:173], v5 offset:12288
    v_mul_f32 v206, v206, v16
    v_mfma_f32_16x16x32_bf16 v[140:143], a[192:195], v[84:87], v[140:143]
    ds_read_b64_tr_b16 a[174:175], v5 offset:14336
    v_mul_f32 v207, v207, v16
    v_mfma_f32_16x16x32_bf16 v[140:143], a[196:199], v[132:135], v[140:143]
    buffer_store_dwordx4 a[104:107], v7, s[16:19], s33 offen sc1
    v_cvt_pk_bf16_f32 v204, v204, v205
    v_mfma_f32_16x16x32_bf16 v[140:143], a[200:203], v[180:183], v[140:143]
    ds_read_b64_tr_b16 a[176:177], v5 offset:16384
    v_cvt_pk_bf16_f32 v205, v206, v207
    v_mfma_f32_16x16x32_bf16 v[140:143], a[204:207], v[228:231], v[140:143]
    ds_read_b64_tr_b16 a[178:179], v5 offset:18432
    v_mfma_f32_16x16x32_bf16 v[140:143], a[208:211], v[44:47], v[140:143]
    ds_read_b64_tr_b16 a[180:181], v5 offset:20480
    v_mfma_f32_16x16x32_bf16 v[140:143], a[212:215], v[124:127], v[140:143]
    ds_read_b64_tr_b16 a[182:183], v5 offset:22528
    v_mfma_f32_16x16x32_bf16 v[140:143], a[216:219], v[24:27], v[140:143]
    ds_write_b64 v3, v[204:205] offset:4608
    v_mfma_f32_16x16x32_bf16 v[140:143], a[220:223], v[48:51], v[140:143]
    ds_read_b64_tr_b16 a[184:185], v5 offset:24576
    v_mul_f32 v172, v172, v12
    v_mfma_f32_16x16x32_bf16 v[108:111], a[192:195], v[100:103], v[108:111]
    ds_read_b64_tr_b16 a[186:187], v5 offset:26624
    v_mul_f32 v173, v173, v12
    v_mfma_f32_16x16x32_bf16 v[108:111], a[196:199], v[148:151], v[108:111]
    ds_read_b64_tr_b16 a[188:189], v5 offset:28672
    v_mul_f32 v174, v174, v12
    v_mfma_f32_16x16x32_bf16 v[108:111], a[200:203], v[196:199], v[108:111]
    ds_read_b64_tr_b16 a[190:191], v5 offset:30720
    v_xor_b32 v5, 32, v5
    v_mfma_f32_16x16x32_bf16 v[108:111], a[204:207], v[244:247], v[108:111]
    v_mul_f32 v175, v175, v12
    v_cvt_pk_bf16_f32 v172, v172, v173
    v_mfma_f32_16x16x32_bf16 v[108:111], a[208:211], v[60:63], v[108:111]
    v_cvt_pk_bf16_f32 v173, v174, v175
    v_mfma_f32_16x16x32_bf16 v[108:111], a[212:215], v[156:159], v[108:111]
    ds_write_b64 v3, v[172:173] offset:32
    v_mfma_f32_16x16x32_bf16 v[108:111], a[216:219], v[32:35], v[108:111]
    buffer_store_dwordx4 a[108:111], v6, s[16:19], s33 offen sc1
    v_mul_f32 v140, v140, v14
    v_mfma_f32_16x16x32_bf16 v[108:111], a[220:223], v[56:59], v[108:111]
    s_waitcnt lgkmcnt(15)
    v_mul_f32 v141, v141, v14
    v_mul_f32 v142, v142, v14
    v_mfma_f32_16x16x32_bf16 v[76:79], a[160:163], v[68:71], v[76:79]
    ds_read_b64_tr_b16 a[192:193], v5 offset:0
    v_mul_f32 v143, v143, v14
    v_mfma_f32_16x16x32_bf16 v[76:79], a[164:167], v[116:119], v[76:79]
    s_waitcnt lgkmcnt(11)
    ds_read_b64_tr_b16 a[194:195], v5 offset:2048
    v_cvt_pk_bf16_f32 v140, v140, v141
    v_mfma_f32_16x16x32_bf16 v[76:79], a[168:171], v[164:167], v[76:79]
    ds_read_b64_tr_b16 a[196:197], v5 offset:4096
    v_cvt_pk_bf16_f32 v141, v142, v143
    v_mfma_f32_16x16x32_bf16 v[76:79], a[172:175], v[212:215], v[76:79]
    s_waitcnt lgkmcnt(9)
    ds_read_b64_tr_b16 a[198:199], v5 offset:6144
    v_mfma_f32_16x16x32_bf16 v[76:79], a[176:179], v[28:31], v[76:79]
    ds_write_b64 v3, v[140:141] offset:2336
    v_mfma_f32_16x16x32_bf16 v[76:79], a[180:183], v[92:95], v[76:79]
    s_waitcnt lgkmcnt(6)
    ds_read_b64_tr_b16 a[200:201], v5 offset:8192
    v_mul_f32 v108, v108, v16
    v_mfma_f32_16x16x32_bf16 v[76:79], a[184:187], v[188:191], v[76:79]
    ds_read_b64_tr_b16 a[202:203], v5 offset:10240
    v_mul_f32 v109, v109, v16
    v_mfma_f32_16x16x32_bf16 v[76:79], a[188:191], v[40:43], v[76:79]
    ds_read_b64_tr_b16 a[204:205], v5 offset:12288
    v_mul_f32 v110, v110, v16
    v_mfma_f32_16x16x32_bf16 v[52:55], a[160:163], v[84:87], v[52:55]
    ds_read_b64_tr_b16 a[206:207], v5 offset:14336
    v_mul_f32 v111, v111, v16
    v_mfma_f32_16x16x32_bf16 v[52:55], a[164:167], v[132:135], v[52:55]
    ds_read_b64_tr_b16 a[208:209], v5 offset:16384
    v_cvt_pk_bf16_f32 v108, v108, v109
    v_mfma_f32_16x16x32_bf16 v[52:55], a[168:171], v[180:183], v[52:55]
    ds_read_b64_tr_b16 a[210:211], v5 offset:18432
    v_cvt_pk_bf16_f32 v109, v110, v111
    v_mfma_f32_16x16x32_bf16 v[52:55], a[172:175], v[228:231], v[52:55]
    ds_read_b64_tr_b16 a[212:213], v5 offset:20480
    v_mfma_f32_16x16x32_bf16 v[52:55], a[176:179], v[44:47], v[52:55]
    ds_read_b64_tr_b16 a[214:215], v5 offset:22528
    v_mfma_f32_16x16x32_bf16 v[52:55], a[180:183], v[124:127], v[52:55]
    ds_read_b64_tr_b16 a[216:217], v5 offset:24576
    v_mfma_f32_16x16x32_bf16 v[52:55], a[184:187], v[24:27], v[52:55]
    ds_write_b64 v3, v[108:109] offset:4640
    v_mfma_f32_16x16x32_bf16 v[52:55], a[188:191], v[48:51], v[52:55]
    ds_read_b64_tr_b16 a[218:219], v5 offset:26624
    v_mul_f32 v76, v76, v12
    v_mfma_f32_16x16x32_bf16 v[36:39], a[160:163], v[100:103], v[36:39]
    ds_read_b64_tr_b16 a[220:221], v5 offset:28672
    v_mul_f32 v77, v77, v12
    v_mfma_f32_16x16x32_bf16 v[36:39], a[164:167], v[148:151], v[36:39]
    ds_read_b64_tr_b16 a[222:223], v5 offset:30720
    v_xor_b32 v5, 0x60, v5
    v_mfma_f32_16x16x32_bf16 v[36:39], a[168:171], v[196:199], v[36:39]
    v_mul_f32 v78, v78, v12
    v_mul_f32 v79, v79, v12
    v_mfma_f32_16x16x32_bf16 v[36:39], a[172:175], v[244:247], v[36:39]
    v_cvt_pk_bf16_f32 v76, v76, v77
    v_cvt_pk_bf16_f32 v77, v78, v79
    v_mfma_f32_16x16x32_bf16 v[36:39], a[176:179], v[60:63], v[36:39]
    ds_write_b64 v3, v[76:77] offset:64
    v_mfma_f32_16x16x32_bf16 v[36:39], a[180:183], v[156:159], v[36:39]
    v_mul_f32 v52, v52, v14
    v_mul_f32 v53, v53, v14
    v_mfma_f32_16x16x32_bf16 v[36:39], a[184:187], v[32:35], v[36:39]
    v_mul_f32 v54, v54, v14
    v_mul_f32 v55, v55, v14
    v_mfma_f32_16x16x32_bf16 v[36:39], a[188:191], v[56:59], v[36:39]
    s_waitcnt lgkmcnt(15)
    v_cvt_pk_bf16_f32 v52, v52, v53
    v_cvt_pk_bf16_f32 v53, v54, v55
    v_mfma_f32_16x16x32_bf16 v[252:255], a[192:195], v[68:71], v[252:255]
    s_waitcnt vmcnt(19)
    s_barrier
    ds_read_b64_tr_b16 a[160:161], v5 offset:32768
    v_mfma_f32_16x16x32_bf16 v[252:255], a[196:199], v[116:119], v[252:255]
    s_waitcnt lgkmcnt(11)
    ds_read_b64_tr_b16 a[162:163], v5 offset:34816
    v_mfma_f32_16x16x32_bf16 v[252:255], a[200:203], v[164:167], v[252:255]
    ds_read_b64_tr_b16 a[164:165], v5 offset:36864
    v_mfma_f32_16x16x32_bf16 v[252:255], a[204:207], v[212:215], v[252:255]
    s_waitcnt lgkmcnt(9)
    ds_read_b64_tr_b16 a[166:167], v5 offset:38912
    v_mfma_f32_16x16x32_bf16 v[252:255], a[208:211], v[28:31], v[252:255]
    ds_write_b64 v3, v[52:53] offset:2368
    v_mfma_f32_16x16x32_bf16 v[252:255], a[212:215], v[92:95], v[252:255]
    s_waitcnt lgkmcnt(6)
    ds_read_b64_tr_b16 a[168:169], v5 offset:40960
    v_mul_f32 v36, v36, v16
    v_mfma_f32_16x16x32_bf16 v[252:255], a[216:219], v[188:191], v[252:255]
    ds_read_b64_tr_b16 a[170:171], v5 offset:43008
    v_mul_f32 v37, v37, v16
    v_mfma_f32_16x16x32_bf16 v[252:255], a[220:223], v[40:43], v[252:255]
    ds_read_b64_tr_b16 a[172:173], v5 offset:45056
    v_mul_f32 v38, v38, v16
    v_mfma_f32_16x16x32_bf16 v[236:239], a[192:195], v[84:87], v[236:239]
    ds_read_b64_tr_b16 a[174:175], v5 offset:47104
    v_mul_f32 v39, v39, v16
    v_mfma_f32_16x16x32_bf16 v[236:239], a[196:199], v[132:135], v[236:239]
    ds_read_b64_tr_b16 a[176:177], v5 offset:49152
    v_cvt_pk_bf16_f32 v36, v36, v37
    v_mfma_f32_16x16x32_bf16 v[236:239], a[200:203], v[180:183], v[236:239]
    ds_read_b64_tr_b16 a[178:179], v5 offset:51200
    v_cvt_pk_bf16_f32 v37, v38, v39
    v_mfma_f32_16x16x32_bf16 v[236:239], a[204:207], v[228:231], v[236:239]
    ds_read_b64_tr_b16 a[180:181], v5 offset:53248
    v_mfma_f32_16x16x32_bf16 v[236:239], a[208:211], v[44:47], v[236:239]
    ds_read_b64_tr_b16 a[182:183], v5 offset:55296
    v_mfma_f32_16x16x32_bf16 v[236:239], a[212:215], v[124:127], v[236:239]
    ds_read_b64_tr_b16 a[184:185], v5 offset:57344
    v_mfma_f32_16x16x32_bf16 v[236:239], a[216:219], v[24:27], v[236:239]
    ds_write_b64 v3, v[36:37] offset:4672
    v_mfma_f32_16x16x32_bf16 v[236:239], a[220:223], v[48:51], v[236:239]
    ds_read_b64_tr_b16 a[186:187], v5 offset:59392
    v_mul_f32 v252, v252, v12
    v_mfma_f32_16x16x32_bf16 v[220:223], a[192:195], v[100:103], v[220:223]
    ds_read_b64_tr_b16 a[188:189], v5 offset:61440
    v_mul_f32 v253, v253, v12
    v_mfma_f32_16x16x32_bf16 v[220:223], a[196:199], v[148:151], v[220:223]
    ds_read_b64_tr_b16 a[190:191], v5 offset:63488
    v_xor_b32 v5, 32, v5
    v_mfma_f32_16x16x32_bf16 v[220:223], a[200:203], v[196:199], v[220:223]
    v_mul_f32 v254, v254, v12
    v_mul_f32 v255, v255, v12
    v_mfma_f32_16x16x32_bf16 v[220:223], a[204:207], v[244:247], v[220:223]
    v_cvt_pk_bf16_f32 v252, v252, v253
    v_cvt_pk_bf16_f32 v253, v254, v255
    v_mfma_f32_16x16x32_bf16 v[220:223], a[208:211], v[60:63], v[220:223]
    ds_write_b64 v3, v[252:253] offset:96
    v_mfma_f32_16x16x32_bf16 v[220:223], a[212:215], v[156:159], v[220:223]
    ds_read_b128 a[64:67], v4 offset:0
    v_mfma_f32_16x16x32_bf16 v[220:223], a[216:219], v[32:35], v[220:223]
    ds_read_b128 a[68:71], v4 offset:1152
    v_mul_f32 v236, v236, v14
    v_mfma_f32_16x16x32_bf16 v[220:223], a[220:223], v[56:59], v[220:223]
    s_waitcnt lgkmcnt(15)
    v_mul_f32 v237, v237, v14
    v_mul_f32 v238, v238, v14
    v_mfma_f32_16x16x32_bf16 v[8:11], a[160:163], v[64:67], 0
    ds_read_b64_tr_b16 a[192:193], v5 offset:32768
    v_mul_f32 v239, v239, v14
    v_mfma_f32_16x16x32_bf16 v[8:11], a[164:167], v[88:91], v[8:11]
    s_waitcnt lgkmcnt(13)
    ds_read_b64_tr_b16 a[194:195], v5 offset:34816
    v_cvt_pk_bf16_f32 v236, v236, v237
    v_mfma_f32_16x16x32_bf16 v[8:11], a[168:171], v[112:115], v[8:11]
    ds_read_b64_tr_b16 a[196:197], v5 offset:36864
    v_cvt_pk_bf16_f32 v237, v238, v239
    v_mfma_f32_16x16x32_bf16 v[8:11], a[172:175], v[136:139], v[8:11]
    s_waitcnt lgkmcnt(11)
    ds_read_b64_tr_b16 a[198:199], v5 offset:38912
    v_mfma_f32_16x16x32_bf16 v[8:11], a[176:179], v[160:163], v[8:11]
    ds_write_b64 v3, v[236:237] offset:2400
    v_mfma_f32_16x16x32_bf16 v[8:11], a[180:183], v[184:187], v[8:11]
    s_waitcnt lgkmcnt(8)
    ds_read_b64_tr_b16 a[200:201], v5 offset:40960
    v_mfma_f32_16x16x32_bf16 v[8:11], a[184:187], v[208:211], v[8:11]
    ds_read_b64_tr_b16 a[202:203], v5 offset:43008
    v_mfma_f32_16x16x32_bf16 v[8:11], a[188:191], v[232:235], v[8:11]
    ds_read_b64_tr_b16 a[204:205], v5 offset:45056
    v_mfma_f32_16x16x32_bf16 v[20:23], a[160:163], v[72:75], 0
    ds_read_b64_tr_b16 a[206:207], v5 offset:47104
    v_mfma_f32_16x16x32_bf16 v[20:23], a[164:167], v[96:99], v[20:23]
    ds_read_b128 a[72:75], v4 offset:2304
    v_mfma_f32_16x16x32_bf16 v[20:23], a[168:171], v[120:123], v[20:23]
    ds_read_b64_tr_b16 a[208:209], v5 offset:49152
    v_mfma_f32_16x16x32_bf16 v[20:23], a[172:175], v[144:147], v[20:23]
    ds_read_b64_tr_b16 a[210:211], v5 offset:51200
    v_mfma_f32_16x16x32_bf16 v[20:23], a[176:179], v[168:171], v[20:23]
    ds_read_b64_tr_b16 a[212:213], v5 offset:53248
    v_mfma_f32_16x16x32_bf16 v[20:23], a[180:183], v[192:195], v[20:23]
    ds_read_b64_tr_b16 a[214:215], v5 offset:55296
    v_mfma_f32_16x16x32_bf16 v[20:23], a[184:187], v[216:219], v[20:23]
    ds_read_b128 a[76:79], v4 offset:3456
    v_mul_f32 v220, v220, v16
    v_mfma_f32_16x16x32_bf16 v[20:23], a[188:191], v[240:243], v[20:23]
    ds_read_b64_tr_b16 a[216:217], v5 offset:57344
    v_mul_f32 v221, v221, v16
    v_mfma_f32_16x16x32_bf16 v[204:207], a[160:163], v[80:83], 0
    ds_read_b64_tr_b16 a[218:219], v5 offset:59392
    v_mul_f32 v222, v222, v16
    v_mfma_f32_16x16x32_bf16 v[204:207], a[164:167], v[104:107], v[204:207]
    ds_read_b64_tr_b16 a[220:221], v5 offset:61440
    v_mul_f32 v223, v223, v16
    v_mfma_f32_16x16x32_bf16 v[204:207], a[168:171], v[128:131], v[204:207]
    ds_read_b64_tr_b16 a[222:223], v5 offset:63488
    v_xor_b32 v5, 0x60, v5
    v_mfma_f32_16x16x32_bf16 v[204:207], a[172:175], v[152:155], v[204:207]
    s_waitcnt lgkmcnt(15)
    buffer_store_dwordx4 a[64:67], v7, s[16:19], s34 offen sc1
    v_cvt_pk_bf16_f32 v220, v220, v221
    v_mfma_f32_16x16x32_bf16 v[204:207], a[176:179], v[176:179], v[204:207]
    v_cvt_pk_bf16_f32 v221, v222, v223
    v_mfma_f32_16x16x32_bf16 v[204:207], a[180:183], v[200:203], v[204:207]
    ds_write_b64 v3, v[220:221] offset:4704
    v_mfma_f32_16x16x32_bf16 v[204:207], a[184:187], v[224:227], v[204:207]
    ds_read_b128 a[80:83], v4 offset:4608
    v_mfma_f32_16x16x32_bf16 v[204:207], a[188:191], v[248:251], v[204:207]
    ds_read_b128 a[84:87], v4 offset:5760
    v_mfma_f32_16x16x32_bf16 v[172:175], a[192:195], v[64:67], 0
    ds_read_b64_tr_b16 a[160:161], v5 offset:32768
    v_mfma_f32_16x16x32_bf16 v[172:175], a[196:199], v[88:91], v[172:175]
    s_waitcnt lgkmcnt(14)
    ds_read_b64_tr_b16 a[162:163], v5 offset:34816
    v_mfma_f32_16x16x32_bf16 v[172:175], a[200:203], v[112:115], v[172:175]
    ds_read_b64_tr_b16 a[164:165], v5 offset:36864
    v_mfma_f32_16x16x32_bf16 v[172:175], a[204:207], v[136:139], v[172:175]
    s_waitcnt lgkmcnt(11)
    ds_read_b64_tr_b16 a[166:167], v5 offset:38912
    v_mfma_f32_16x16x32_bf16 v[172:175], a[208:211], v[160:163], v[172:175]
    ds_read_b64_tr_b16 a[168:169], v5 offset:40960
    v_mfma_f32_16x16x32_bf16 v[172:175], a[212:215], v[184:187], v[172:175]
    s_waitcnt lgkmcnt(8)
    ds_read_b64_tr_b16 a[170:171], v5 offset:43008
    v_mfma_f32_16x16x32_bf16 v[172:175], a[216:219], v[208:211], v[172:175]
    ds_read_b64_tr_b16 a[172:173], v5 offset:45056
    v_mfma_f32_16x16x32_bf16 v[172:175], a[220:223], v[232:235], v[172:175]
    ds_read_b64_tr_b16 a[174:175], v5 offset:47104
    v_mfma_f32_16x16x32_bf16 v[140:143], a[192:195], v[72:75], 0
    ds_read_b64_tr_b16 a[176:177], v5 offset:49152
    v_mfma_f32_16x16x32_bf16 v[140:143], a[196:199], v[96:99], v[140:143]
    buffer_store_dwordx4 a[68:71], v6, s[16:19], s34 offen sc1
    v_mfma_f32_16x16x32_bf16 v[140:143], a[200:203], v[120:123], v[140:143]
    ds_read_b64_tr_b16 a[178:179], v5 offset:51200
    v_mfma_f32_16x16x32_bf16 v[140:143], a[204:207], v[144:147], v[140:143]
    ds_read_b64_tr_b16 a[180:181], v5 offset:53248
    v_mfma_f32_16x16x32_bf16 v[140:143], a[208:211], v[168:171], v[140:143]
    ds_read_b64_tr_b16 a[182:183], v5 offset:55296
    v_mfma_f32_16x16x32_bf16 v[140:143], a[212:215], v[192:195], v[140:143]
    ds_read_b64_tr_b16 a[184:185], v5 offset:57344
    v_mfma_f32_16x16x32_bf16 v[140:143], a[216:219], v[216:219], v[140:143]
    ds_read_b64_tr_b16 a[186:187], v5 offset:59392
    v_mfma_f32_16x16x32_bf16 v[140:143], a[220:223], v[240:243], v[140:143]
    ds_read_b64_tr_b16 a[188:189], v5 offset:61440
    v_mfma_f32_16x16x32_bf16 v[108:111], a[192:195], v[80:83], 0
    ds_read_b64_tr_b16 a[190:191], v5 offset:63488
    v_xor_b32 v5, 32, v5
    v_mfma_f32_16x16x32_bf16 v[108:111], a[196:199], v[104:107], v[108:111]
    v_mfma_f32_16x16x32_bf16 v[108:111], a[200:203], v[128:131], v[108:111]
    v_mfma_f32_16x16x32_bf16 v[108:111], a[204:207], v[152:155], v[108:111]
    v_mfma_f32_16x16x32_bf16 v[108:111], a[208:211], v[176:179], v[108:111]
    v_mfma_f32_16x16x32_bf16 v[108:111], a[212:215], v[200:203], v[108:111]
    buffer_store_dwordx4 a[72:75], v7, s[16:19], s35 offen sc1
    v_mfma_f32_16x16x32_bf16 v[108:111], a[216:219], v[224:227], v[108:111]
    v_mfma_f32_16x16x32_bf16 v[108:111], a[220:223], v[248:251], v[108:111]
    s_waitcnt lgkmcnt(12)
    v_mfma_f32_16x16x32_bf16 v[76:79], a[160:163], v[64:67], 0
    ds_read_b64_tr_b16 a[192:193], v5 offset:32768
    v_mfma_f32_16x16x32_bf16 v[76:79], a[164:167], v[88:91], v[76:79]
    s_waitcnt lgkmcnt(9)
    ds_read_b64_tr_b16 a[194:195], v5 offset:34816
    v_mfma_f32_16x16x32_bf16 v[76:79], a[168:171], v[112:115], v[76:79]
    ds_read_b64_tr_b16 a[196:197], v5 offset:36864
    v_mfma_f32_16x16x32_bf16 v[76:79], a[172:175], v[136:139], v[76:79]
    s_waitcnt lgkmcnt(7)
    ds_read_b64_tr_b16 a[198:199], v5 offset:38912
    v_mfma_f32_16x16x32_bf16 v[76:79], a[176:179], v[160:163], v[76:79]
    ds_read_b64_tr_b16 a[200:201], v5 offset:40960
    v_mfma_f32_16x16x32_bf16 v[76:79], a[180:183], v[184:187], v[76:79]
    s_waitcnt lgkmcnt(5)
    ds_read_b64_tr_b16 a[202:203], v5 offset:43008
    v_mfma_f32_16x16x32_bf16 v[76:79], a[184:187], v[208:211], v[76:79]
    ds_read_b64_tr_b16 a[204:205], v5 offset:45056
    v_mfma_f32_16x16x32_bf16 v[76:79], a[188:191], v[232:235], v[76:79]
    ds_read_b64_tr_b16 a[206:207], v5 offset:47104
    v_mfma_f32_16x16x32_bf16 v[52:55], a[160:163], v[72:75], 0
    ds_read_b64_tr_b16 a[208:209], v5 offset:49152
    v_mfma_f32_16x16x32_bf16 v[52:55], a[164:167], v[96:99], v[52:55]
    buffer_store_dwordx4 a[76:79], v6, s[16:19], s35 offen sc1
    v_mfma_f32_16x16x32_bf16 v[52:55], a[168:171], v[120:123], v[52:55]
    ds_read_b64_tr_b16 a[210:211], v5 offset:51200
    v_mfma_f32_16x16x32_bf16 v[52:55], a[172:175], v[144:147], v[52:55]
    ds_read_b64_tr_b16 a[212:213], v5 offset:53248
    v_mfma_f32_16x16x32_bf16 v[52:55], a[176:179], v[168:171], v[52:55]
    ds_read_b64_tr_b16 a[214:215], v5 offset:55296
    v_mfma_f32_16x16x32_bf16 v[52:55], a[180:183], v[192:195], v[52:55]
    ds_read_b64_tr_b16 a[216:217], v5 offset:57344
    v_mfma_f32_16x16x32_bf16 v[52:55], a[184:187], v[216:219], v[52:55]
    ds_read_b64_tr_b16 a[218:219], v5 offset:59392
    v_mfma_f32_16x16x32_bf16 v[52:55], a[188:191], v[240:243], v[52:55]
    ds_read_b64_tr_b16 a[220:221], v5 offset:61440
    v_mfma_f32_16x16x32_bf16 v[36:39], a[160:163], v[80:83], 0
    ds_read_b64_tr_b16 a[222:223], v5 offset:63488
    v_add_u32 v5, 0x10000, v5
    v_mfma_f32_16x16x32_bf16 v[36:39], a[164:167], v[104:107], v[36:39]
    v_xor_b32 v5, 0x60, v5
    v_mfma_f32_16x16x32_bf16 v[36:39], a[168:171], v[128:131], v[36:39]
    v_mfma_f32_16x16x32_bf16 v[36:39], a[172:175], v[152:155], v[36:39]
    v_mfma_f32_16x16x32_bf16 v[36:39], a[176:179], v[176:179], v[36:39]
    v_mfma_f32_16x16x32_bf16 v[36:39], a[180:183], v[200:203], v[36:39]
    buffer_store_dwordx4 a[80:83], v7, s[16:19], s36 offen sc1
    v_mfma_f32_16x16x32_bf16 v[36:39], a[184:187], v[224:227], v[36:39]
    v_mfma_f32_16x16x32_bf16 v[36:39], a[188:191], v[248:251], v[36:39]
    s_waitcnt lgkmcnt(12)
    v_mfma_f32_16x16x32_bf16 v[252:255], a[192:195], v[64:67], 0
    s_waitcnt vmcnt(12)
    s_barrier
L_pg8:
    s_cbranch_execz L_warm_done
    ds_read_b64_tr_b16 a[160:161], v5 offset:0
    v_mfma_f32_16x16x32_bf16 v[252:255], a[196:199], v[88:91], v[252:255]
    s_waitcnt lgkmcnt(9)
    ds_read_b64_tr_b16 a[162:163], v5 offset:2048
    v_mfma_f32_16x16x32_bf16 v[252:255], a[200:203], v[112:115], v[252:255]
    ds_read_b64_tr_b16 a[164:165], v5 offset:4096
    v_mfma_f32_16x16x32_bf16 v[252:255], a[204:207], v[136:139], v[252:255]
    s_waitcnt lgkmcnt(7)
    ds_read_b64_tr_b16 a[166:167], v5 offset:6144
    v_mfma_f32_16x16x32_bf16 v[252:255], a[208:211], v[160:163], v[252:255]
    ds_read_b64_tr_b16 a[168:169], v5 offset:8192
    v_mfma_f32_16x16x32_bf16 v[252:255], a[212:215], v[184:187], v[252:255]
    s_waitcnt lgkmcnt(5)
    ds_read_b64_tr_b16 a[170:171], v5 offset:10240
    v_mfma_f32_16x16x32_bf16 v[252:255], a[216:219], v[208:211], v[252:255]
    ds_read_b64_tr_b16 a[172:173], v5 offset:12288
    v_mfma_f32_16x16x32_bf16 v[252:255], a[220:223], v[232:235], v[252:255]
    ds_read_b64_tr_b16 a[174:175], v5 offset:14336
    v_mfma_f32_16x16x32_bf16 v[236:239], a[192:195], v[72:75], 0
    ds_read_b64_tr_b16 a[176:177], v5 offset:16384
    v_mfma_f32_16x16x32_bf16 v[236:239], a[196:199], v[96:99], v[236:239]
    buffer_store_dwordx4 a[84:87], v6, s[16:19], s36 offen sc1
    v_mfma_f32_16x16x32_bf16 v[236:239], a[200:203], v[120:123], v[236:239]
    ds_read_b64_tr_b16 a[178:179], v5 offset:18432
    v_mfma_f32_16x16x32_bf16 v[236:239], a[204:207], v[144:147], v[236:239]
    ds_read_b64_tr_b16 a[180:181], v5 offset:20480
    v_mfma_f32_16x16x32_bf16 v[236:239], a[208:211], v[168:171], v[236:239]
    ds_read_b64_tr_b16 a[182:183], v5 offset:22528
    v_mfma_f32_16x16x32_bf16 v[236:239], a[212:215], v[192:195], v[236:239]
    ds_read_b64_tr_b16 a[184:185], v5 offset:24576
    v_mfma_f32_16x16x32_bf16 v[236:239], a[216:219], v[216:219], v[236:239]
    ds_read_b64_tr_b16 a[186:187], v5 offset:26624
    v_mfma_f32_16x16x32_bf16 v[236:239], a[220:223], v[240:243], v[236:239]
    ds_read_b64_tr_b16 a[188:189], v5 offset:28672
    v_mfma_f32_16x16x32_bf16 v[220:223], a[192:195], v[80:83], 0
    ds_read_b64_tr_b16 a[190:191], v5 offset:30720
    v_xor_b32 v5, 32, v5
    v_mfma_f32_16x16x32_bf16 v[220:223], a[196:199], v[104:107], v[220:223]
    ds_read_b64_tr_b16 a[0:1], v5 offset:0
    v_mfma_f32_16x16x32_bf16 v[220:223], a[200:203], v[128:131], v[220:223]
    ds_read_b64_tr_b16 a[2:3], v5 offset:2048
    v_mfma_f32_16x16x32_bf16 v[220:223], a[204:207], v[152:155], v[220:223]
    ds_read_b64_tr_b16 a[4:5], v5 offset:4096
    v_mfma_f32_16x16x32_bf16 v[220:223], a[208:211], v[176:179], v[220:223]
    ds_read_b64_tr_b16 a[6:7], v5 offset:6144
    v_mfma_f32_16x16x32_bf16 v[220:223], a[212:215], v[200:203], v[220:223]
    ds_read_b64_tr_b16 a[8:9], v5 offset:8192
    v_mfma_f32_16x16x32_bf16 v[220:223], a[216:219], v[224:227], v[220:223]
    ds_read_b64_tr_b16 a[10:11], v5 offset:10240
    v_mfma_f32_16x16x32_bf16 v[220:223], a[220:223], v[248:251], v[220:223]
    s_waitcnt lgkmcnt(15)
    ds_read_b64_tr_b16 a[12:13], v5 offset:12288
    v_mfma_f32_16x16x32_bf16 v[8:11], a[160:163], v[68:71], v[8:11]
    ds_read_b64_tr_b16 a[14:15], v5 offset:14336
    v_mfma_f32_16x16x32_bf16 v[8:11], a[164:167], v[116:119], v[8:11]
    s_waitcnt lgkmcnt(15)
    ds_read_b64_tr_b16 a[16:17], v5 offset:16384
    v_mfma_f32_16x16x32_bf16 v[8:11], a[168:171], v[164:167], v[8:11]
    ds_read_b64_tr_b16 a[18:19], v5 offset:18432
    v_mfma_f32_16x16x32_bf16 v[8:11], a[172:175], v[212:215], v[8:11]
    s_waitcnt lgkmcnt(14)
    ds_read_b64_tr_b16 a[20:21], v5 offset:20480
    v_mfma_f32_16x16x32_bf16 v[8:11], a[176:179], v[28:31], v[8:11]
    ds_read_b64_tr_b16 a[22:23], v5 offset:22528
    v_mfma_f32_16x16x32_bf16 v[8:11], a[180:183], v[92:95], v[8:11]
    s_waitcnt lgkmcnt(12)
    ds_read_b64_tr_b16 a[24:25], v5 offset:24576
    v_mfma_f32_16x16x32_bf16 v[8:11], a[184:187], v[188:191], v[8:11]
    ds_read_b64_tr_b16 a[26:27], v5 offset:26624
    v_mfma_f32_16x16x32_bf16 v[8:11], a[188:191], v[40:43], v[8:11]
    ds_read_b64_tr_b16 a[28:29], v5 offset:28672
    v_mfma_f32_16x16x32_bf16 v[20:23], a[160:163], v[84:87], v[20:23]
    ds_read_b64_tr_b16 a[30:31], v5 offset:30720
    v_xor_b32 v5, 0x60, v5
    v_mfma_f32_16x16x32_bf16 v[20:23], a[164:167], v[132:135], v[20:23]
    ds_read_b64_tr_b16 a[32:33], v5 offset:0
    v_mfma_f32_16x16x32_bf16 v[20:23], a[168:171], v[180:183], v[20:23]
    ds_read_b64_tr_b16 a[34:35], v5 offset:2048
    v_mfma_f32_16x16x32_bf16 v[20:23], a[172:175], v[228:231], v[20:23]
    ds_read_b64_tr_b16 a[36:37], v5 offset:4096
    v_mfma_f32_16x16x32_bf16 v[20:23], a[176:179], v[44:47], v[20:23]
    ds_read_b64_tr_b16 a[38:39], v5 offset:6144
    v_mfma_f32_16x16x32_bf16 v[20:23], a[180:183], v[124:127], v[20:23]
    ds_read_b64_tr_b16 a[40:41], v5 offset:8192
    v_mul_f32 v8, v8, v12
    v_mfma_f32_16x16x32_bf16 v[20:23], a[184:187], v[24:27], v[20:23]
    ds_read_b64_tr_b16 a[42:43], v5 offset:10240
    v_mul_f32 v9, v9, v12
    v_mfma_f32_16x16x32_bf16 v[20:23], a[188:191], v[48:51], v[20:23]
    s_waitcnt lgkmcnt(15)
    ds_read_b64_tr_b16 a[44:45], v5 offset:12288
    v_mul_f32 v10, v10, v12
    v_mfma_f32_16x16x32_bf16 v[172:175], a[0:3], v[68:71], v[172:175]
    ds_read_b64_tr_b16 a[46:47], v5 offset:14336
    v_mul_f32 v11, v11, v12
    v_mfma_f32_16x16x32_bf16 v[172:175], a[4:7], v[116:119], v[172:175]
    s_waitcnt lgkmcnt(15)
    ds_read_b64_tr_b16 a[48:49], v5 offset:16384
    v_cvt_pk_bf16_f32 v8, v8, v9
    v_mfma_f32_16x16x32_bf16 v[172:175], a[8:11], v[164:167], v[172:175]
    ds_read_b64_tr_b16 a[50:51], v5 offset:18432
    v_cvt_pk_bf16_f32 v9, v10, v11
    v_mfma_f32_16x16x32_bf16 v[172:175], a[12:15], v[212:215], v[172:175]
    s_waitcnt lgkmcnt(14)
    ds_read_b64_tr_b16 a[52:53], v5 offset:20480
    v_mfma_f32_16x16x32_bf16 v[172:175], a[16:19], v[28:31], v[172:175]
    ds_read_b64_tr_b16 a[54:55], v5 offset:22528
    v_mfma_f32_16x16x32_bf16 v[172:175], a[20:23], v[92:95], v[172:175]
    s_waitcnt lgkmcnt(12)
    ds_read_b64_tr_b16 a[56:57], v5 offset:24576
    v_mfma_f32_16x16x32_bf16 v[172:175], a[24:27], v[188:191], v[172:175]
    ds_write_b64 v3, v[8:9] offset:0
    v_mfma_f32_16x16x32_bf16 v[172:175], a[28:31], v[40:43], v[172:175]
    ds_read_b64_tr_b16 a[58:59], v5 offset:26624
    v_mul_f32 v20, v20, v14
    v_mfma_f32_16x16x32_bf16 v[140:143], a[0:3], v[84:87], v[140:143]
    ds_read_b64_tr_b16 a[60:61], v5 offset:28672
    v_mul_f32 v21, v21, v14
    v_mfma_f32_16x16x32_bf16 v[140:143], a[4:7], v[132:135], v[140:143]
    ds_read_b64_tr_b16 a[62:63], v5 offset:30720
    v_xor_b32 v5, 32, v5
    v_mfma_f32_16x16x32_bf16 v[140:143], a[8:11], v[180:183], v[140:143]
    ds_read_b64_tr_b16 a[192:193], v5 offset:0
    v_mul_f32 v22, v22, v14
    v_mfma_f32_16x16x32_bf16 v[140:143], a[12:15], v[228:231], v[140:143]
    ds_read_b64_tr_b16 a[194:195], v5 offset:2048
    v_mul_f32 v23, v23, v14
    v_mfma_f32_16x16x32_bf16 v[140:143], a[16:19], v[44:47], v[140:143]
    ds_read_b64_tr_b16 a[196:197], v5 offset:4096
    v_cvt_pk_bf16_f32 v20, v20, v21
    v_mfma_f32_16x16x32_bf16 v[140:143], a[20:23], v[124:127], v[140:143]
    ds_read_b64_tr_b16 a[198:199], v5 offset:6144
    v_cvt_pk_bf16_f32 v21, v22, v23
    v_mfma_f32_16x16x32_bf16 v[140:143], a[24:27], v[24:27], v[140:143]
    ds_read_b64_tr_b16 a[200:201], v5 offset:8192
    v_mfma_f32_16x16x32_bf16 v[140:143], a[28:31], v[48:51], v[140:143]
    s_waitcnt lgkmcnt(15)
    ds_read_b64_tr_b16 a[202:203], v5 offset:10240
    v_mfma_f32_16x16x32_bf16 v[76:79], a[32:35], v[68:71], v[76:79]
    ds_write_b64 v3, v[20:21] offset:2304
    v_mfma_f32_16x16x32_bf16 v[76:79], a[36:39], v[116:119], v[76:79]
    s_waitcnt lgkmcnt(15)
    ds_read_b64_tr_b16 a[204:205], v5 offset:12288
    v_mul_f32 v172, v172, v12
    v_mfma_f32_16x16x32_bf16 v[76:79], a[40:43], v[164:167], v[76:79]
    ds_read_b64_tr_b16 a[206:207], v5 offset:14336
    v_mul_f32 v173, v173, v12
    v_mfma_f32_16x16x32_bf16 v[76:79], a[44:47], v[212:215], v[76:79]
    s_waitcnt lgkmcnt(14)
    ds_read_b64_tr_b16 a[208:209], v5 offset:16384
    v_mul_f32 v174, v174, v12
    v_mfma_f32_16x16x32_bf16 v[76:79], a[48:51], v[28:31], v[76:79]
    ds_read_b64_tr_b16 a[210:211], v5 offset:18432
    v_mul_f32 v175, v175, v12
    v_mfma_f32_16x16x32_bf16 v[76:79], a[52:55], v[92:95], v[76:79]
    s_waitcnt lgkmcnt(11)
    ds_read_b64_tr_b16 a[212:213], v5 offset:20480
    v_cvt_pk_bf16_f32 v172, v172, v173
    v_mfma_f32_16x16x32_bf16 v[76:79], a[56:59], v[188:191], v[76:79]
    ds_read_b64_tr_b16 a[214:215], v5 offset:22528
    v_cvt_pk_bf16_f32 v173, v174, v175
    v_mfma_f32_16x16x32_bf16 v[76:79], a[60:63], v[40:43], v[76:79]
    ds_read_b64_tr_b16 a[216:217], v5 offset:24576
    v_mfma_f32_16x16x32_bf16 v[52:55], a[32:35], v[84:87], v[52:55]
    ds_read_b64_tr_b16 a[218:219], v5 offset:26624
    v_mfma_f32_16x16x32_bf16 v[52:55], a[36:39], v[132:135], v[52:55]
    ds_read_b64_tr_b16 a[220:221], v5 offset:28672
    v_mfma_f32_16x16x32_bf16 v[52:55], a[40:43], v[180:183], v[52:55]
    ds_write_b64 v3, v[172:173] offset:32
    v_mfma_f32_16x16x32_bf16 v[52:55], a[44:47], v[228:231], v[52:55]
    ds_read_b64_tr_b16 a[222:223], v5 offset:30720
    v_mul_f32 v140, v140, v14
    v_mfma_f32_16x16x32_bf16 v[52:55], a[48:51], v[44:47], v[52:55]
    v_mul_f32 v141, v141, v14
    v_mul_f32 v142, v142, v14
    v_mfma_f32_16x16x32_bf16 v[52:55], a[52:55], v[124:127], v[52:55]
    v_mul_f32 v143, v143, v14
    v_cvt_pk_bf16_f32 v140, v140, v141
    v_mfma_f32_16x16x32_bf16 v[52:55], a[56:59], v[24:27], v[52:55]
    v_cvt_pk_bf16_f32 v141, v142, v143
    v_mfma_f32_16x16x32_bf16 v[52:55], a[60:63], v[48:51], v[52:55]
    s_waitcnt lgkmcnt(14)
    ds_write_b64 v3, v[140:141] offset:2336
    v_mfma_f32_16x16x32_bf16 v[252:255], a[192:195], v[68:71], v[252:255]
    v_mul_f32 v76, v76, v12
    v_mul_f32 v77, v77, v12
    v_mfma_f32_16x16x32_bf16 v[252:255], a[196:199], v[116:119], v[252:255]
    s_waitcnt lgkmcnt(10)
    v_mul_f32 v78, v78, v12
    v_mul_f32 v79, v79, v12
    v_mfma_f32_16x16x32_bf16 v[252:255], a[200:203], v[164:167], v[252:255]
    v_cvt_pk_bf16_f32 v76, v76, v77
    v_cvt_pk_bf16_f32 v77, v78, v79
    v_mfma_f32_16x16x32_bf16 v[252:255], a[204:207], v[212:215], v[252:255]
    s_waitcnt lgkmcnt(6)
    ds_write_b64 v3, v[76:77] offset:64
    v_mfma_f32_16x16x32_bf16 v[252:255], a[208:211], v[28:31], v[252:255]
    v_mfma_f32_16x16x32_bf16 v[252:255], a[212:215], v[92:95], v[252:255]
    s_waitcnt lgkmcnt(2)
    v_mul_f32 v52, v52, v14
    v_mul_f32 v53, v53, v14
    v_mfma_f32_16x16x32_bf16 v[252:255], a[216:219], v[188:191], v[252:255]
    v_mul_f32 v54, v54, v14
    v_mul_f32 v55, v55, v14
    v_mfma_f32_16x16x32_bf16 v[252:255], a[220:223], v[40:43], v[252:255]
    v_cvt_pk_bf16_f32 v52, v52, v53
    v_cvt_pk_bf16_f32 v53, v54, v55
    v_mfma_f32_16x16x32_bf16 v[236:239], a[192:195], v[84:87], v[236:239]
    ds_write_b64 v3, v[52:53] offset:2368
    v_mfma_f32_16x16x32_bf16 v[236:239], a[196:199], v[132:135], v[236:239]
    v_mfma_f32_16x16x32_bf16 v[236:239], a[200:203], v[180:183], v[236:239]
    v_mfma_f32_16x16x32_bf16 v[236:239], a[204:207], v[228:231], v[236:239]
    v_mfma_f32_16x16x32_bf16 v[236:239], a[208:211], v[44:47], v[236:239]
    v_mfma_f32_16x16x32_bf16 v[236:239], a[212:215], v[124:127], v[236:239]
    v_mul_f32 v252, v252, v12
    v_mul_f32 v253, v253, v12
    v_mfma_f32_16x16x32_bf16 v[236:239], a[216:219], v[24:27], v[236:239]
    v_mul_f32 v254, v254, v12
    v_mul_f32 v255, v255, v12
    v_mfma_f32_16x16x32_bf16 v[236:239], a[220:223], v[48:51], v[236:239]
    v_cvt_pk_bf16_f32 v252, v252, v253
    v_cvt_pk_bf16_f32 v253, v254, v255
    v_mfma_f32_16x16x32_bf16 v[204:207], a[160:163], v[100:103], v[204:207]
    ds_write_b64 v3, v[252:253] offset:96
    v_mfma_f32_16x16x32_bf16 v[204:207], a[164:167], v[148:151], v[204:207]
    ds_read_b128 a[88:91], v4 offset:0
    v_mfma_f32_16x16x32_bf16 v[204:207], a[168:171], v[196:199], v[204:207]
    ds_read_b128 a[92:95], v4 offset:1152
    v_mfma_f32_16x16x32_bf16 v[204:207], a[172:175], v[244:247], v[204:207]
    v_mfma_f32_16x16x32_bf16 v[204:207], a[176:179], v[60:63], v[204:207]
    v_mfma_f32_16x16x32_bf16 v[204:207], a[180:183], v[156:159], v[204:207]
    v_mul_f32 v236, v236, v14
    v_mul_f32 v237, v237, v14
    v_mfma_f32_16x16x32_bf16 v[204:207], a[184:187], v[32:35], v[204:207]
    s_waitcnt lgkmcnt(1)
    buffer_store_dwordx4 a[88:91], v7, s[16:19], s37 offen sc1
    v_mul_f32 v238, v238, v14
    v_mfma_f32_16x16x32_bf16 v[204:207], a[188:191], v[56:59], v[204:207]
    v_mul_f32 v239, v239, v14
    v_cvt_pk_bf16_f32 v236, v236, v237
    v_mfma_f32_16x16x32_bf16 v[108:111], a[0:3], v[100:103], v[108:111]
    s_waitcnt lgkmcnt(0)
    buffer_store_dwordx4 a[92:95], v6, s[16:19], s37 offen sc1
    v_cvt_pk_bf16_f32 v237, v238, v239
    v_mfma_f32_16x16x32_bf16 v[108:111], a[4:7], v[148:151], v[108:111]
    ds_write_b64 v3, v[236:237] offset:2400
    v_mfma_f32_16x16x32_bf16 v[108:111], a[8:11], v[196:199], v[108:111]
    ds_read_b128 a[96:99], v4 offset:2304
    v_mfma_f32_16x16x32_bf16 v[108:111], a[12:15], v[244:247], v[108:111]
    ds_read_b128 a[100:103], v4 offset:3456
    v_mfma_f32_16x16x32_bf16 v[108:111], a[16:19], v[60:63], v[108:111]
    v_mfma_f32_16x16x32_bf16 v[108:111], a[20:23], v[156:159], v[108:111]
    v_mul_f32 v204, v204, v16
    v_mul_f32 v205, v205, v16
    v_mfma_f32_16x16x32_bf16 v[108:111], a[24:27], v[32:35], v[108:111]
    v_mul_f32 v206, v206, v16
    v_mul_f32 v207, v207, v16
    v_mfma_f32_16x16x32_bf16 v[108:111], a[28:31], v[56:59], v[108:111]
    s_waitcnt lgkmcnt(1)
    buffer_store_dwordx4 a[96:99], v7, s[16:19], s38 offen sc1
    v_cvt_pk_bf16_f32 v204, v204, v205
    v_mfma_f32_16x16x32_bf16 v[36:39], a[32:35], v[100:103], v[36:39]
    v_cvt_pk_bf16_f32 v205, v206, v207
    v_mfma_f32_16x16x32_bf16 v[36:39], a[36:39], v[148:151], v[36:39]
    ds_write_b64 v3, v[204:205] offset:4608
    v_mfma_f32_16x16x32_bf16 v[36:39], a[40:43], v[196:199], v[36:39]
    s_waitcnt lgkmcnt(1)
    buffer_store_dwordx4 a[100:103], v6, s[16:19], s38 offen sc1
    v_mfma_f32_16x16x32_bf16 v[36:39], a[44:47], v[244:247], v[36:39]
    v_mfma_f32_16x16x32_bf16 v[36:39], a[48:51], v[60:63], v[36:39]
    v_mfma_f32_16x16x32_bf16 v[36:39], a[52:55], v[156:159], v[36:39]
    v_mul_f32 v108, v108, v16
    v_mul_f32 v109, v109, v16
    v_mfma_f32_16x16x32_bf16 v[36:39], a[56:59], v[32:35], v[36:39]
    v_mul_f32 v110, v110, v16
    v_mul_f32 v111, v111, v16
    v_mfma_f32_16x16x32_bf16 v[36:39], a[60:63], v[56:59], v[36:39]
    v_cvt_pk_bf16_f32 v108, v108, v109
    v_cvt_pk_bf16_f32 v109, v110, v111
    v_mfma_f32_16x16x32_bf16 v[220:223], a[192:195], v[100:103], v[220:223]
    ds_write_b64 v3, v[108:109] offset:4640
    v_mfma_f32_16x16x32_bf16 v[220:223], a[196:199], v[148:151], v[220:223]
    v_mfma_f32_16x16x32_bf16 v[220:223], a[200:203], v[196:199], v[220:223]
    v_mfma_f32_16x16x32_bf16 v[220:223], a[204:207], v[244:247], v[220:223]
    v_mfma_f32_16x16x32_bf16 v[220:223], a[208:211], v[60:63], v[220:223]
    v_mfma_f32_16x16x32_bf16 v[220:223], a[212:215], v[156:159], v[220:223]
    v_mul_f32 v36, v36, v16
    v_mul_f32 v37, v37, v16
    v_mfma_f32_16x16x32_bf16 v[220:223], a[216:219], v[32:35], v[220:223]
    v_mul_f32 v38, v38, v16
    v_mul_f32 v39, v39, v16
    v_mfma_f32_16x16x32_bf16 v[220:223], a[220:223], v[56:59], v[220:223]
    v_cvt_pk_bf16_f32 v36, v36, v37
    v_cvt_pk_bf16_f32 v37, v38, v39
    s_nop 7
    ds_write_b64 v3, v[36:37] offset:4672
    v_mul_f32 v220, v220, v16
    v_mul_f32 v221, v221, v16
    v_mul_f32 v222, v222, v16
    v_mul_f32 v223, v223, v16
    v_cvt_pk_bf16_f32 v220, v220, v221
    v_cvt_pk_bf16_f32 v221, v222, v223
    ds_write_b64 v3, v[220:221] offset:4704
    ds_read_b128 a[104:107], v4 offset:4608
    ds_read_b128 a[108:111], v4 offset:5760
    s_waitcnt lgkmcnt(1)
    buffer_store_dwordx4 a[104:107], v7, s[16:19], s39 offen sc1
    s_waitcnt lgkmcnt(0)
    buffer_store_dwordx4 a[108:111], v6, s[16:19], s39 offen sc1
L_end:
    s_endpgm
.section .rodata,"a"
.p2align 6
.amdhsa_kernel standalone__gqa_softmax__near_ridge_kernel
  .amdhsa_next_free_vgpr 512
  .amdhsa_next_free_sgpr 102
  .amdhsa_accum_offset 256
  .amdhsa_group_segment_fixed_size 0
  .amdhsa_kernarg_size 48
  .amdhsa_user_sgpr_count 2
  .amdhsa_user_sgpr_kernarg_segment_ptr 1
  .amdhsa_system_sgpr_workgroup_id_x 1
.end_amdhsa_kernel
```
